```python
import torch

def _softmax(x, axis=-1):
    return torch.softmax(x, dim=axis)
def _gelu(x):
    return torch.nn.functional.gelu(x, approximate="tanh")
def _silu(x):
    return torch.nn.functional.silu(x)
def _sigmoid(x):
    return torch.sigmoid(x)
def _layernorm(x, axis=-1, eps=1e-5):
    m = x.mean(dim=axis, keepdim=True)
    v = x.var(dim=axis, keepdim=True, unbiased=False)
    return (x - m) / torch.sqrt(v + eps)
def _scatter_add(tgt, idx, src, axis=0):
    return tgt.clone().index_add_(axis, idx, src)
def _segment_sum(src, seg, n):
    out = torch.zeros((n,) + src.shape[1:], dtype=src.dtype)
    return out.index_add_(0, seg, src)
def _pad(x, pw):
    flat = tuple(v for pair in reversed(pw) for v in pair)
    return torch.nn.functional.pad(x, flat)

kernel_name = 'standalone__glu_gated_reglu__prompt'

def setup_inputs():

    _w = (lambda a: (lambda t: t.to(torch.bfloat16) if t.is_floating_point() else t)(torch.as_tensor(a)))
    B, S, D, F = 1, 2048, 512, 1792
    return {
        "x": _w((lambda *s: torch.randn(*s, dtype=torch.bfloat16) * 0.05)(B, S, D)),
        "W_gate": _w((lambda *s: torch.randn(*s, dtype=torch.bfloat16) * 0.05)(D, F) * (2.0 / D) ** 0.5),
        "W_up": _w((lambda *s: torch.randn(*s, dtype=torch.bfloat16) * 0.05)(D, F) * (2.0 / D) ** 0.5),
        "W_down": _w((lambda *s: torch.randn(*s, dtype=torch.bfloat16) * 0.05)(F, D) * (1.0 / F) ** 0.5),
    }

def reference(x, W_gate, W_up, W_down):
    gate = torch.einsum("bsd,df->bsf", x, W_gate)
    up = torch.einsum("bsd,df->bsf", x, W_up)
    gate = gate * (lambda x, dt: x.to(dt))(gate > 0, gate.dtype)
    h = gate * up
    return torch.einsum("bsf,fd->bsd", h, W_down)
```

```asm
; @launch grid=(256,1,1) block=(256,1,1) lds=163840
.amdgcn_target "amdgcn-amd-amdhsa--gfx950"
.text
.globl standalone__glu_gated_reglu__prompt_kernel
.p2align 8
.type standalone__glu_gated_reglu__prompt_kernel,@function
standalone__glu_gated_reglu__prompt_kernel:
    s_cmp_ge_u32 s2, 256
    s_cbranch_scc1 L_end
    s_load_dwordx8 s[4:11], s[0:1], 0
    s_load_dwordx2 s[12:13], s[0:1], 32
    s_load_dwordx2 s[16:17], s[0:1], 48
    v_lshrrev_b32 v1, 6, v0
    v_and_b32 v2, 63, v0
    v_readfirstlane_b32 s3, v1
    s_bfe_u32 s43, s2, 0x10002
    s_lshr_b32 s41, s2, 5
    s_bfe_u32 s78, s2, 0x20003
    s_and_b32 s40, s2, 3
    s_lshl_b32 s40, s40, 2
    s_add_u32 s40, s40, s78
    s_mul_i32 s83, s43, 7
    s_add_u32 s83, s83, s41
    s_lshl_b32 s82, s78, 1
    s_add_u32 s82, s82, s41
    v_lshrrev_b32 v3, 3, v2
    v_and_b32 v4, 7, v2
    v_lshrrev_b32 v5, 4, v2
    s_lshl_b32 s44, s3, 14
    s_add_u32 s44, s44, 98304
    v_mov_b32 v45, 0
    s_mul_i32 s15, s40, 1048576
    s_add_u32 s15, s15, 722432
    s_cmp_eq_u32 s41, 7
    s_cbranch_scc1 L_spare
    s_lshl_b32 s79, s78, 1
    s_add_u32 s79, s79, 0
    s_mov_b32 s81, s41
    s_and_b32 s79, s79, 7
    s_lshl_b32 s48, s79, 7
    s_mul_i32 s56, s79, 229376
    s_mov_b32 vcc_lo, 0x17654321
    s_mov_b32 vcc_hi, 0x765432
    s_lshl_b32 s81, s81, 2
    s_lshr_b64 vcc, vcc, s81
    s_mul_i32 s79, s79, 0x1111111
    s_add_u32 s81, vcc_lo, s79
    s_bfe_u32 s79, s81, 0x30000
    s_lshl_b32 s49, s79, 7
    s_mul_i32 s57, s79, 229376
    s_bfe_u32 s79, s81, 0x30004
    s_lshl_b32 s50, s79, 7
    s_mul_i32 s58, s79, 229376
    s_bfe_u32 s79, s81, 0x30008
    s_lshl_b32 s51, s79, 7
    s_mul_i32 s59, s79, 229376
    s_bfe_u32 s79, s81, 0x3000c
    s_lshl_b32 s52, s79, 7
    s_mul_i32 s60, s79, 229376
    s_bfe_u32 s79, s81, 0x30010
    s_lshl_b32 s53, s79, 7
    s_mul_i32 s61, s79, 229376
    s_bfe_u32 s79, s81, 0x30014
    s_lshl_b32 s54, s79, 7
    s_mul_i32 s62, s79, 229376
    s_bfe_u32 s79, s81, 0x30018
    s_lshl_b32 s55, s79, 7
    s_mul_i32 s63, s79, 229376
    s_lshl_b32 s78, s40, 2
    s_add_u32 s78, s78, s3
    s_lshl_b32 s79, s78, 15
    v_xor_b32 v6, v4, v5
    v_lshlrev_b32 v6, 4, v6
    v_lshlrev_b32 v7, 10, v3
    v_add3_u32 v8, v7, v6, s79
    v_xor_b32 v9, 64, v8
    v_add_u32 v9, 7168, v9
    v_add_u32 v10, 14336, v8
    v_add_u32 v11, 14336, v9
    s_mul_i32 s45, s3, 114688
    s_mul_i32 s79, s83, 8192
    s_add_u32 s45, s45, s79
    s_mul_i32 s79, s40, 1048576
    s_add_u32 s45, s45, s79
    s_add_u32 s46, s45, 4096
    s_lshr_b32 s78, s3, 1
    s_and_b32 s79, s3, 1
    v_and_b32 v6, 1, v5
    v_lshlrev_b32 v6, 1, v6
    v_xor_b32 v6, v6, v4
    s_lshl_b32 s80, s78, 2
    v_xor_b32 v6, s80, v6
    v_lshlrev_b32 v6, 4, v6
    v_mul_u32_u24 v7, 3584, v3
    s_mul_i32 s80, s79, 114688
    s_lshl_b32 s81, s83, 8
    s_add_u32 s80, s80, s81
    v_add3_u32 v12, v7, v6, s80
    v_add_u32 v13, 27648, v12
    v_add_u32 v14, 55296, v12
    v_add_u32 v15, 82944, v12
    s_lshl_b32 s42, s3, 12
    s_waitcnt lgkmcnt(0)
    s_mov_b32 s20, s4
    s_mov_b32 s21, s5
    s_mov_b32 s22, 2097152
    s_mov_b32 s23, 0x00020000
    s_cmp_lt_u32 s3, 2
    s_cselect_b32 s24, s6, s8
    s_cselect_b32 s25, s7, s9
    s_mov_b32 s26, 1835008
    s_mov_b32 s27, 0x00020000
    s_add_u32 m0, s44, 0
    s_nop 0
    buffer_load_dwordx4 v8, s[20:23], s48 offen lds
    buffer_load_dwordx4 v9, s[20:23], s48 offen offset:1024 lds
    buffer_load_dwordx4 v10, s[20:23], s48 offen offset:2048 lds
    buffer_load_dwordx4 v11, s[20:23], s48 offen offset:3072 lds
    s_add_u32 m0, s42, 0
    s_nop 0
    buffer_load_dwordx4 v12, s[24:27], s56 offen lds
    buffer_load_dwordx4 v13, s[24:27], s56 offen offset:1024 lds
    buffer_load_dwordx4 v14, s[24:27], s56 offen offset:2048 lds
    buffer_load_dwordx4 v15, s[24:27], s56 offen offset:3072 lds
    s_add_u32 m0, s44, 4096
    s_nop 0
    buffer_load_dwordx4 v8, s[20:23], s49 offen lds
    buffer_load_dwordx4 v9, s[20:23], s49 offen offset:1024 lds
    buffer_load_dwordx4 v10, s[20:23], s49 offen offset:2048 lds
    buffer_load_dwordx4 v11, s[20:23], s49 offen offset:3072 lds
    s_mov_b32 s28, s16
    s_mov_b32 s29, s17
    s_mov_b32 s30, 18874368
    s_mov_b32 s31, 0x00020000
    v_add_u32 v16, 128, v12
    v_add_u32 v17, 128, v13
    v_add_u32 v18, 128, v14
    v_add_u32 v19, 128, v15
    v_and_b32 v6, 31, v2
    v_bfe_u32 v7, v2, 1, 3
    v_lshrrev_b32 v1, 5, v2
    v_xor_b32 v7, v7, v1
    v_lshlrev_b32 v7, 4, v7
    v_lshlrev_b32 v6, 7, v6
    v_add3_u32 v28, v6, v7, s44
    v_xor_b32 v29, 32, v28
    v_xor_b32 v30, 64, v28
    v_xor_b32 v31, 96, v28
    v_and_b32 v3, 1, v5
    v_bfe_u32 v4, v2, 2, 2
    v_lshlrev_b32 v6, 3, v1
    v_add_u32 v6, v6, v4
    v_and_b32 v7, 3, v2
    v_lshlrev_b32 v7, 3, v7
    v_lshlrev_b32 v32, 7, v6
    v_mul_u32_u24 v33, 8256, v3
    v_add3_u32 v32, v32, v33, v7
    v_bfe_u32 v6, v2, 3, 1
    v_lshlrev_b32 v6, 5, v6
    v_add_u32 v32, v32, v6
    v_xor_b32 v33, 32, v32
    v_xor_b32 v34, 64, v32
    v_xor_b32 v35, 96, v32
    v_add_u32 v36, 65536, v32
    v_add_u32 v37, 65536, v33
    v_add_u32 v38, 65536, v34
    v_add_u32 v39, 65536, v35
    s_lshr_b32 s79, s3, 1
    s_lshl_b32 s79, s79, 8
    s_lshl_b32 s80, s83, 3
    s_add_u32 s79, s79, s80
    s_and_b32 s80, s3, 1
    s_lshl_b32 s80, s80, 2
    s_add_u32 s79, s79, s80
    s_add_u32 s79, s79, s15
    s_sub_u32 s47, s79, 1024
    v_lshrrev_b32 v1, 5, v2
    v_bfe_u32 v4, v2, 2, 2
    v_bfe_u32 v3, v2, 4, 1
    v_and_b32 v7, 3, v2
    v_lshlrev_b32 v7, 3, v7
    v_lshlrev_b32 v6, 2, v1
    v_add_u32 v6, v6, v4
    v_lshlrev_b32 v6, 7, v6
    v_bfe_u32 v4, v2, 3, 1
    v_lshlrev_b32 v4, 6, v4
    v_lshlrev_b32 v3, 5, v3
    v_add3_u32 v6, v6, v4, v3
    v_add3_u32 v40, v6, v7, s44
    v_xor_b32 v41, 64, v40
    s_add_u32 s81, s41, 6
    s_and_b32 s81, s81, 7
    s_lshl_b32 s79, s81, 7
    s_lshl_b32 s80, s3, 14
    s_add_u32 s79, s79, s80
    v_lshrrev_b32 v3, 3, v2
    v_and_b32 v4, 7, v2
    v_bfe_u32 v6, v2, 4, 1
    v_lshlrev_b32 v6, 2, v6
    v_xor_b32 v4, v4, v6
    v_lshlrev_b32 v4, 4, v4
    v_lshlrev_b32 v3, 10, v3
    v_add3_u32 v20, v3, v4, s79
    v_add_u32 v21, 7168, v20
    v_add_u32 v22, 65536, v20
    v_add_u32 v23, 65536, v21
    s_cmp_ge_u32 s82, 7
    s_cselect_b32 s79, 7, 0
    s_sub_u32 s78, s82, s79
    s_lshl_b32 s78, s78, 10
    s_mul_i32 s79, s43, 7168
    s_sub_u32 s80, 7168, s79
    s_add_u32 s64, s78, s79
    s_add_u32 s71, s78, s80
    s_add_u32 s78, s78, 1024
    s_cmp_eq_u32 s78, 7168
    s_cselect_b32 s78, 0, s78
    s_add_u32 s65, s78, s79
    s_add_u32 s72, s78, s80
    s_add_u32 s78, s78, 1024
    s_cmp_eq_u32 s78, 7168
    s_cselect_b32 s78, 0, s78
    s_add_u32 s66, s78, s79
    s_add_u32 s73, s78, s80
    s_add_u32 s78, s78, 1024
    s_cmp_eq_u32 s78, 7168
    s_cselect_b32 s78, 0, s78
    s_add_u32 s67, s78, s79
    s_add_u32 s74, s78, s80
    s_add_u32 s78, s78, 1024
    s_cmp_eq_u32 s78, 7168
    s_cselect_b32 s78, 0, s78
    s_add_u32 s68, s78, s79
    s_add_u32 s75, s78, s80
    s_add_u32 s78, s78, 1024
    s_cmp_eq_u32 s78, 7168
    s_cselect_b32 s78, 0, s78
    s_add_u32 s69, s78, s79
    s_add_u32 s76, s78, s80
    s_add_u32 s78, s78, 1024
    s_cmp_eq_u32 s78, 7168
    s_cselect_b32 s78, 0, s78
    s_add_u32 s70, s78, s79
    s_add_u32 s77, s78, s80
    s_lshl_b32 s78, s40, 1
    s_add_u32 s78, s78, s43
    s_mul_i32 s79, s43, 229376
    s_lshl_b32 s80, s3, 10
    s_add_u32 s79, s79, s80
    s_mul_i32 s80, s40, 1048576
    s_add_u32 s79, s79, s80
    v_lshlrev_b32 v46, 4, v2
    v_add_u32 v24, s79, v46
    v_add_u32 v25, 114688, v24
    v_add_u32 v26, 4096, v24
    v_add_u32 v27, 4096, v25
    s_lshl_b32 s79, s43, 8
    s_add_u32 s79, s79, s15
    s_sub_u32 s79, s79, 1024
    v_min_u32 v3, 29, v2
    v_lshlrev_b32 v3, 2, v3
    v_add_u32 v44, s79, v3
    s_cmp_eq_u32 s43, 0
    s_mov_b32 s79, 0x10003fff
    s_mov_b32 s80, 0x2fffc000
    s_cselect_b32 s18, s79, s80
    s_cselect_b32 s19, s80, s79
    s_mov_b32 s32, s10
    s_mov_b32 s33, s11
    s_mov_b32 s34, 1835008
    s_mov_b32 s35, 0x00020000
    s_mov_b32 s36, s12
    s_mov_b32 s37, s13
    s_mov_b32 s38, 2097152
    s_mov_b32 s39, 0x00020000
    s_lshl_b32 s14, s78, 16
    s_lshl_b32 s79, s81, 7
    s_add_u32 s14, s14, s79
    s_add_u32 m0, s42, 16384
    s_nop 0
    buffer_load_dwordx4 v12, s[24:27], s57 offen lds
    buffer_load_dwordx4 v13, s[24:27], s57 offen offset:1024 lds
    buffer_load_dwordx4 v14, s[24:27], s57 offen offset:2048 lds
    buffer_load_dwordx4 v15, s[24:27], s57 offen offset:3072 lds
    s_waitcnt vmcnt(8)
    s_barrier
    ds_read_b128 a[0:3], v28 offset:0
    ds_read_b128 a[4:7], v29 offset:0
    ds_read_b128 a[8:11], v30 offset:0
    ds_read_b128 a[12:15], v31 offset:0
    ds_read_b64_tr_b16 v[56:57], v32 offset:0
    ds_read_b64_tr_b16 v[58:59], v32 offset:512
    ds_read_b64_tr_b16 v[60:61], v33 offset:0
    ds_read_b64_tr_b16 v[62:63], v33 offset:512
    ds_read_b64_tr_b16 v[64:65], v34 offset:0
    ds_read_b64_tr_b16 v[66:67], v34 offset:512
    ds_read_b64_tr_b16 v[68:69], v35 offset:0
    ds_read_b64_tr_b16 v[70:71], v35 offset:512
    ds_read_b64_tr_b16 v[72:73], v32 offset:2048
    ds_read_b64_tr_b16 v[74:75], v32 offset:2560
    ds_read_b64_tr_b16 v[76:77], v33 offset:2048
    ds_read_b64_tr_b16 v[78:79], v33 offset:2560
    s_waitcnt lgkmcnt(10)
    v_mfma_f32_32x32x16_bf16 v[88:103], v[56:59], a[0:3], 0
    ds_read_b64_tr_b16 v[80:81], v34 offset:2048
    ds_read_b64_tr_b16 v[82:83], v34 offset:2560
    s_add_u32 m0, s44, 8192
    s_waitcnt lgkmcnt(10)
    v_mfma_f32_32x32x16_bf16 v[104:119], v[60:63], a[0:3], 0
    buffer_load_dwordx4 v8, s[20:23], s50 offen lds
    ds_read_b64_tr_b16 v[84:85], v35 offset:2048
    ds_read_b64_tr_b16 v[86:87], v35 offset:2560
    s_waitcnt lgkmcnt(10)
    v_mfma_f32_32x32x16_bf16 v[120:135], v[64:67], a[0:3], 0
    ds_read_b64_tr_b16 v[56:57], v32 offset:4096
    ds_read_b64_tr_b16 v[58:59], v32 offset:4608
    s_waitcnt lgkmcnt(10)
    v_mfma_f32_32x32x16_bf16 v[136:151], v[68:71], a[0:3], 0
    buffer_load_dwordx4 v9, s[20:23], s50 offen offset:1024 lds
    ds_read_b64_tr_b16 v[60:61], v33 offset:4096
    ds_read_b64_tr_b16 v[62:63], v33 offset:4608
    s_waitcnt lgkmcnt(10)
    v_mfma_f32_32x32x16_bf16 v[88:103], v[72:75], a[4:7], v[88:103]
    ds_read_b64_tr_b16 v[64:65], v34 offset:4096
    ds_read_b64_tr_b16 v[66:67], v34 offset:4608
    s_waitcnt lgkmcnt(10)
    v_mfma_f32_32x32x16_bf16 v[104:119], v[76:79], a[4:7], v[104:119]
    buffer_load_dwordx4 v10, s[20:23], s50 offen offset:2048 lds
    ds_read_b64_tr_b16 v[68:69], v35 offset:4096
    ds_read_b64_tr_b16 v[70:71], v35 offset:4608
    s_waitcnt lgkmcnt(10)
    v_mfma_f32_32x32x16_bf16 v[120:135], v[80:83], a[4:7], v[120:135]
    ds_read_b64_tr_b16 v[72:73], v32 offset:6144
    ds_read_b64_tr_b16 v[74:75], v32 offset:6656
    s_waitcnt lgkmcnt(10)
    v_mfma_f32_32x32x16_bf16 v[136:151], v[84:87], a[4:7], v[136:151]
    buffer_load_dwordx4 v11, s[20:23], s50 offen offset:3072 lds
    ds_read_b64_tr_b16 v[76:77], v33 offset:6144
    ds_read_b64_tr_b16 v[78:79], v33 offset:6656
    s_waitcnt lgkmcnt(10)
    v_mfma_f32_32x32x16_bf16 v[88:103], v[56:59], a[8:11], v[88:103]
    ds_read_b64_tr_b16 v[80:81], v34 offset:6144
    ds_read_b64_tr_b16 v[82:83], v34 offset:6656
    s_add_u32 m0, s42, 32768
    s_waitcnt lgkmcnt(10)
    v_mfma_f32_32x32x16_bf16 v[104:119], v[60:63], a[8:11], v[104:119]
    buffer_load_dwordx4 v12, s[24:27], s58 offen lds
    ds_read_b64_tr_b16 v[84:85], v35 offset:6144
    ds_read_b64_tr_b16 v[86:87], v35 offset:6656
    s_waitcnt lgkmcnt(10)
    v_mfma_f32_32x32x16_bf16 v[120:135], v[64:67], a[8:11], v[120:135]
    s_waitcnt vmcnt(5)
    s_barrier
    ds_read_b128 a[16:19], v28 offset:4096
    ds_read_b128 a[20:23], v29 offset:4096
    ds_read_b128 a[24:27], v30 offset:4096
    ds_read_b128 a[28:31], v31 offset:4096
    ds_read_b64_tr_b16 v[56:57], v32 offset:16384
    ds_read_b64_tr_b16 v[58:59], v32 offset:16896
    s_waitcnt lgkmcnt(14)
    v_mfma_f32_32x32x16_bf16 v[136:151], v[68:71], a[8:11], v[136:151]
    buffer_load_dwordx4 v13, s[24:27], s58 offen offset:1024 lds
    ds_read_b64_tr_b16 v[60:61], v33 offset:16384
    ds_read_b64_tr_b16 v[62:63], v33 offset:16896
    s_waitcnt lgkmcnt(14)
    v_mfma_f32_32x32x16_bf16 v[88:103], v[72:75], a[12:15], v[88:103]
    ds_read_b64_tr_b16 v[64:65], v34 offset:16384
    ds_read_b64_tr_b16 v[66:67], v34 offset:16896
    s_waitcnt lgkmcnt(14)
    v_mfma_f32_32x32x16_bf16 v[104:119], v[76:79], a[12:15], v[104:119]
    buffer_load_dwordx4 v14, s[24:27], s58 offen offset:2048 lds
    ds_read_b64_tr_b16 v[68:69], v35 offset:16384
    ds_read_b64_tr_b16 v[70:71], v35 offset:16896
    s_waitcnt lgkmcnt(14)
    v_mfma_f32_32x32x16_bf16 v[120:135], v[80:83], a[12:15], v[120:135]
    ds_read_b64_tr_b16 v[72:73], v32 offset:18432
    ds_read_b64_tr_b16 v[74:75], v32 offset:18944
    s_waitcnt lgkmcnt(14)
    v_mfma_f32_32x32x16_bf16 v[136:151], v[84:87], a[12:15], v[136:151]
    buffer_load_dwordx4 v15, s[24:27], s58 offen offset:3072 lds
    ds_read_b64_tr_b16 v[76:77], v33 offset:18432
    ds_read_b64_tr_b16 v[78:79], v33 offset:18944
    s_waitcnt lgkmcnt(10)
    v_mfma_f32_32x32x16_bf16 v[88:103], v[56:59], a[16:19], v[88:103]
    ds_read_b64_tr_b16 v[80:81], v34 offset:18432
    ds_read_b64_tr_b16 v[82:83], v34 offset:18944
    s_waitcnt lgkmcnt(10)
    v_mfma_f32_32x32x16_bf16 v[104:119], v[60:63], a[16:19], v[104:119]
    buffer_load_dword v42, v45, s[28:31], s15 offen sc1
    buffer_load_dword v47, v45, s[32:35], s64 offen
    buffer_load_dword v47, v45, s[36:39], s14 offen
    ds_read_b64_tr_b16 v[84:85], v35 offset:18432
    ds_read_b64_tr_b16 v[86:87], v35 offset:18944
    s_waitcnt lgkmcnt(10)
    v_mfma_f32_32x32x16_bf16 v[120:135], v[64:67], a[16:19], v[120:135]
    ds_read_b64_tr_b16 v[56:57], v32 offset:20480
    ds_read_b64_tr_b16 v[58:59], v32 offset:20992
    s_add_u32 m0, s44, 12288
    s_waitcnt lgkmcnt(10)
    v_mfma_f32_32x32x16_bf16 v[136:151], v[68:71], a[16:19], v[136:151]
    buffer_load_dwordx4 v8, s[20:23], s51 offen lds
    ds_read_b64_tr_b16 v[60:61], v33 offset:20480
    ds_read_b64_tr_b16 v[62:63], v33 offset:20992
    s_waitcnt lgkmcnt(10)
    v_mfma_f32_32x32x16_bf16 v[88:103], v[72:75], a[20:23], v[88:103]
    ds_read_b64_tr_b16 v[64:65], v34 offset:20480
    ds_read_b64_tr_b16 v[66:67], v34 offset:20992
    s_waitcnt lgkmcnt(10)
    v_mfma_f32_32x32x16_bf16 v[104:119], v[76:79], a[20:23], v[104:119]
    buffer_load_dwordx4 v9, s[20:23], s51 offen offset:1024 lds
    ds_read_b64_tr_b16 v[68:69], v35 offset:20480
    ds_read_b64_tr_b16 v[70:71], v35 offset:20992
    s_waitcnt lgkmcnt(10)
    v_mfma_f32_32x32x16_bf16 v[120:135], v[80:83], a[20:23], v[120:135]
    ds_read_b64_tr_b16 v[72:73], v32 offset:22528
    ds_read_b64_tr_b16 v[74:75], v32 offset:23040
    s_waitcnt lgkmcnt(10)
    v_mfma_f32_32x32x16_bf16 v[136:151], v[84:87], a[20:23], v[136:151]
    buffer_load_dwordx4 v10, s[20:23], s51 offen offset:2048 lds
    ds_read_b64_tr_b16 v[76:77], v33 offset:22528
    ds_read_b64_tr_b16 v[78:79], v33 offset:23040
    s_waitcnt lgkmcnt(10)
    v_mfma_f32_32x32x16_bf16 v[88:103], v[56:59], a[24:27], v[88:103]
    ds_read_b64_tr_b16 v[80:81], v34 offset:22528
    ds_read_b64_tr_b16 v[82:83], v34 offset:23040
    s_waitcnt lgkmcnt(10)
    v_mfma_f32_32x32x16_bf16 v[104:119], v[60:63], a[24:27], v[104:119]
    buffer_load_dwordx4 v11, s[20:23], s51 offen offset:3072 lds
    ds_read_b64_tr_b16 v[84:85], v35 offset:22528
    ds_read_b64_tr_b16 v[86:87], v35 offset:23040
    s_waitcnt lgkmcnt(10)
    v_mfma_f32_32x32x16_bf16 v[120:135], v[64:67], a[24:27], v[120:135]
    s_waitcnt vmcnt(7)
    s_barrier
    ds_read_b128 a[32:35], v28 offset:8192
    ds_read_b128 a[36:39], v29 offset:8192
    ds_read_b128 a[40:43], v30 offset:8192
    ds_read_b128 a[44:47], v31 offset:8192
    ds_read_b64_tr_b16 v[56:57], v32 offset:32768
    ds_read_b64_tr_b16 v[58:59], v32 offset:33280
    s_add_u32 m0, s42, 49152
    s_waitcnt lgkmcnt(14)
    v_mfma_f32_32x32x16_bf16 v[136:151], v[68:71], a[24:27], v[136:151]
    buffer_load_dwordx4 v12, s[24:27], s59 offen lds
    ds_read_b64_tr_b16 v[60:61], v33 offset:32768
    ds_read_b64_tr_b16 v[62:63], v33 offset:33280
    s_waitcnt lgkmcnt(14)
    v_mfma_f32_32x32x16_bf16 v[88:103], v[72:75], a[28:31], v[88:103]
    ds_read_b64_tr_b16 v[64:65], v34 offset:32768
    ds_read_b64_tr_b16 v[66:67], v34 offset:33280
    s_waitcnt lgkmcnt(14)
    v_mfma_f32_32x32x16_bf16 v[104:119], v[76:79], a[28:31], v[104:119]
    buffer_load_dwordx4 v13, s[24:27], s59 offen offset:1024 lds
    ds_read_b64_tr_b16 v[68:69], v35 offset:32768
    ds_read_b64_tr_b16 v[70:71], v35 offset:33280
    s_waitcnt lgkmcnt(14)
    v_mfma_f32_32x32x16_bf16 v[120:135], v[80:83], a[28:31], v[120:135]
    ds_read_b64_tr_b16 v[72:73], v32 offset:34816
    ds_read_b64_tr_b16 v[74:75], v32 offset:35328
    s_waitcnt lgkmcnt(14)
    v_mfma_f32_32x32x16_bf16 v[136:151], v[84:87], a[28:31], v[136:151]
    buffer_load_dwordx4 v14, s[24:27], s59 offen offset:2048 lds
    ds_read_b64_tr_b16 v[76:77], v33 offset:34816
    ds_read_b64_tr_b16 v[78:79], v33 offset:35328
    s_waitcnt lgkmcnt(10)
    v_mfma_f32_32x32x16_bf16 v[88:103], v[56:59], a[32:35], v[88:103]
    ds_read_b64_tr_b16 v[80:81], v34 offset:34816
    ds_read_b64_tr_b16 v[82:83], v34 offset:35328
    s_waitcnt lgkmcnt(10)
    v_mfma_f32_32x32x16_bf16 v[104:119], v[60:63], a[32:35], v[104:119]
    buffer_load_dwordx4 v15, s[24:27], s59 offen offset:3072 lds
    ds_read_b64_tr_b16 v[84:85], v35 offset:34816
    ds_read_b64_tr_b16 v[86:87], v35 offset:35328
    s_waitcnt lgkmcnt(10)
    v_mfma_f32_32x32x16_bf16 v[120:135], v[64:67], a[32:35], v[120:135]
    ds_read_b64_tr_b16 v[56:57], v32 offset:36864
    ds_read_b64_tr_b16 v[58:59], v32 offset:37376
    s_add_u32 m0, s44, 0
    s_waitcnt lgkmcnt(10)
    v_mfma_f32_32x32x16_bf16 v[136:151], v[68:71], a[32:35], v[136:151]
    buffer_load_dwordx4 v8, s[20:23], s52 offen lds
    ds_read_b64_tr_b16 v[60:61], v33 offset:36864
    ds_read_b64_tr_b16 v[62:63], v33 offset:37376
    s_waitcnt lgkmcnt(10)
    v_mfma_f32_32x32x16_bf16 v[88:103], v[72:75], a[36:39], v[88:103]
    ds_read_b64_tr_b16 v[64:65], v34 offset:36864
    ds_read_b64_tr_b16 v[66:67], v34 offset:37376
    s_waitcnt lgkmcnt(10)
    v_mfma_f32_32x32x16_bf16 v[104:119], v[76:79], a[36:39], v[104:119]
    buffer_load_dwordx4 v9, s[20:23], s52 offen offset:1024 lds
    ds_read_b64_tr_b16 v[68:69], v35 offset:36864
    ds_read_b64_tr_b16 v[70:71], v35 offset:37376
    s_waitcnt lgkmcnt(10)
    v_mfma_f32_32x32x16_bf16 v[120:135], v[80:83], a[36:39], v[120:135]
    ds_read_b64_tr_b16 v[72:73], v32 offset:38912
    ds_read_b64_tr_b16 v[74:75], v32 offset:39424
    s_waitcnt lgkmcnt(10)
    v_mfma_f32_32x32x16_bf16 v[136:151], v[84:87], a[36:39], v[136:151]
    buffer_load_dwordx4 v10, s[20:23], s52 offen offset:2048 lds
    ds_read_b64_tr_b16 v[76:77], v33 offset:38912
    ds_read_b64_tr_b16 v[78:79], v33 offset:39424
    s_waitcnt lgkmcnt(10)
    v_mfma_f32_32x32x16_bf16 v[88:103], v[56:59], a[40:43], v[88:103]
    ds_read_b64_tr_b16 v[80:81], v34 offset:38912
    ds_read_b64_tr_b16 v[82:83], v34 offset:39424
    s_waitcnt lgkmcnt(10)
    v_mfma_f32_32x32x16_bf16 v[104:119], v[60:63], a[40:43], v[104:119]
    buffer_load_dwordx4 v11, s[20:23], s52 offen offset:3072 lds
    ds_read_b64_tr_b16 v[84:85], v35 offset:38912
    ds_read_b64_tr_b16 v[86:87], v35 offset:39424
    s_waitcnt lgkmcnt(10)
    v_mfma_f32_32x32x16_bf16 v[120:135], v[64:67], a[40:43], v[120:135]
    s_waitcnt vmcnt(4)
    s_barrier
    ds_read_b128 a[48:51], v28 offset:12288
    ds_read_b128 a[52:55], v29 offset:12288
    ds_read_b128 a[56:59], v30 offset:12288
    ds_read_b128 a[60:63], v31 offset:12288
    ds_read_b64_tr_b16 v[56:57], v32 offset:49152
    ds_read_b64_tr_b16 v[58:59], v32 offset:49664
    s_add_u32 m0, s42, 65536
    s_waitcnt lgkmcnt(14)
    v_mfma_f32_32x32x16_bf16 v[136:151], v[68:71], a[40:43], v[136:151]
    buffer_load_dwordx4 v12, s[24:27], s60 offen lds
    ds_read_b64_tr_b16 v[60:61], v33 offset:49152
    ds_read_b64_tr_b16 v[62:63], v33 offset:49664
    s_waitcnt lgkmcnt(14)
    v_mfma_f32_32x32x16_bf16 v[88:103], v[72:75], a[44:47], v[88:103]
    ds_read_b64_tr_b16 v[64:65], v34 offset:49152
    ds_read_b64_tr_b16 v[66:67], v34 offset:49664
    s_waitcnt lgkmcnt(14)
    v_mfma_f32_32x32x16_bf16 v[104:119], v[76:79], a[44:47], v[104:119]
    buffer_load_dwordx4 v13, s[24:27], s60 offen offset:1024 lds
    ds_read_b64_tr_b16 v[68:69], v35 offset:49152
    ds_read_b64_tr_b16 v[70:71], v35 offset:49664
    s_waitcnt lgkmcnt(14)
    v_mfma_f32_32x32x16_bf16 v[120:135], v[80:83], a[44:47], v[120:135]
    ds_read_b64_tr_b16 v[72:73], v32 offset:51200
    ds_read_b64_tr_b16 v[74:75], v32 offset:51712
    s_waitcnt lgkmcnt(14)
    v_mfma_f32_32x32x16_bf16 v[136:151], v[84:87], a[44:47], v[136:151]
    buffer_load_dwordx4 v14, s[24:27], s60 offen offset:2048 lds
    ds_read_b64_tr_b16 v[76:77], v33 offset:51200
    ds_read_b64_tr_b16 v[78:79], v33 offset:51712
    s_waitcnt lgkmcnt(10)
    v_mfma_f32_32x32x16_bf16 v[88:103], v[56:59], a[48:51], v[88:103]
    ds_read_b64_tr_b16 v[80:81], v34 offset:51200
    ds_read_b64_tr_b16 v[82:83], v34 offset:51712
    s_waitcnt lgkmcnt(10)
    v_mfma_f32_32x32x16_bf16 v[104:119], v[60:63], a[48:51], v[104:119]
    buffer_load_dwordx4 v15, s[24:27], s60 offen offset:3072 lds
    ds_read_b64_tr_b16 v[84:85], v35 offset:51200
    ds_read_b64_tr_b16 v[86:87], v35 offset:51712
    s_waitcnt lgkmcnt(10)
    v_mfma_f32_32x32x16_bf16 v[120:135], v[64:67], a[48:51], v[120:135]
    ds_read_b64_tr_b16 v[56:57], v32 offset:53248
    ds_read_b64_tr_b16 v[58:59], v32 offset:53760
    s_add_u32 m0, s44, 4096
    s_waitcnt lgkmcnt(10)
    v_mfma_f32_32x32x16_bf16 v[136:151], v[68:71], a[48:51], v[136:151]
    buffer_load_dwordx4 v8, s[20:23], s53 offen lds
    ds_read_b64_tr_b16 v[60:61], v33 offset:53248
    ds_read_b64_tr_b16 v[62:63], v33 offset:53760
    s_waitcnt lgkmcnt(10)
    v_mfma_f32_32x32x16_bf16 v[88:103], v[72:75], a[52:55], v[88:103]
    ds_read_b64_tr_b16 v[64:65], v34 offset:53248
    ds_read_b64_tr_b16 v[66:67], v34 offset:53760
    s_waitcnt lgkmcnt(10)
    v_mfma_f32_32x32x16_bf16 v[104:119], v[76:79], a[52:55], v[104:119]
    buffer_load_dwordx4 v9, s[20:23], s53 offen offset:1024 lds
    ds_read_b64_tr_b16 v[68:69], v35 offset:53248
    ds_read_b64_tr_b16 v[70:71], v35 offset:53760
    s_waitcnt lgkmcnt(10)
    v_mfma_f32_32x32x16_bf16 v[120:135], v[80:83], a[52:55], v[120:135]
    ds_read_b64_tr_b16 v[72:73], v32 offset:55296
    ds_read_b64_tr_b16 v[74:75], v32 offset:55808
    s_waitcnt lgkmcnt(10)
    v_mfma_f32_32x32x16_bf16 v[136:151], v[84:87], a[52:55], v[136:151]
    buffer_load_dwordx4 v10, s[20:23], s53 offen offset:2048 lds
    ds_read_b64_tr_b16 v[76:77], v33 offset:55296
    ds_read_b64_tr_b16 v[78:79], v33 offset:55808
    s_waitcnt lgkmcnt(10)
    v_mfma_f32_32x32x16_bf16 v[88:103], v[56:59], a[56:59], v[88:103]
    ds_read_b64_tr_b16 v[80:81], v34 offset:55296
    ds_read_b64_tr_b16 v[82:83], v34 offset:55808
    s_waitcnt lgkmcnt(10)
    v_mfma_f32_32x32x16_bf16 v[104:119], v[60:63], a[56:59], v[104:119]
    buffer_load_dwordx4 v11, s[20:23], s53 offen offset:3072 lds
    ds_read_b64_tr_b16 v[84:85], v35 offset:55296
    ds_read_b64_tr_b16 v[86:87], v35 offset:55808
    s_waitcnt lgkmcnt(10)
    v_mfma_f32_32x32x16_bf16 v[120:135], v[64:67], a[56:59], v[120:135]
    s_waitcnt vmcnt(4)
    s_barrier
    ds_read_b128 a[64:67], v28 offset:0
    ds_read_b128 a[68:71], v29 offset:0
    ds_read_b128 a[72:75], v30 offset:0
    ds_read_b128 a[76:79], v31 offset:0
    ds_read_b64_tr_b16 v[56:57], v36 offset:0
    ds_read_b64_tr_b16 v[58:59], v36 offset:512
    s_add_u32 m0, s42, 81920
    s_waitcnt lgkmcnt(14)
    v_mfma_f32_32x32x16_bf16 v[136:151], v[68:71], a[56:59], v[136:151]
    buffer_load_dwordx4 v12, s[24:27], s61 offen lds
    ds_read_b64_tr_b16 v[60:61], v37 offset:0
    ds_read_b64_tr_b16 v[62:63], v37 offset:512
    s_waitcnt lgkmcnt(14)
    v_mfma_f32_32x32x16_bf16 v[88:103], v[72:75], a[60:63], v[88:103]
    ds_read_b64_tr_b16 v[64:65], v38 offset:0
    ds_read_b64_tr_b16 v[66:67], v38 offset:512
    s_waitcnt lgkmcnt(14)
    v_mfma_f32_32x32x16_bf16 v[104:119], v[76:79], a[60:63], v[104:119]
    buffer_load_dwordx4 v13, s[24:27], s61 offen offset:1024 lds
    ds_read_b64_tr_b16 v[68:69], v39 offset:0
    ds_read_b64_tr_b16 v[70:71], v39 offset:512
    s_waitcnt lgkmcnt(14)
    v_mfma_f32_32x32x16_bf16 v[120:135], v[80:83], a[60:63], v[120:135]
    ds_read_b64_tr_b16 v[72:73], v36 offset:2048
    ds_read_b64_tr_b16 v[74:75], v36 offset:2560
    s_waitcnt lgkmcnt(14)
    v_mfma_f32_32x32x16_bf16 v[136:151], v[84:87], a[60:63], v[136:151]
    buffer_load_dwordx4 v14, s[24:27], s61 offen offset:2048 lds
    ds_read_b64_tr_b16 v[76:77], v37 offset:2048
    ds_read_b64_tr_b16 v[78:79], v37 offset:2560
    s_waitcnt lgkmcnt(10)
    v_mfma_f32_32x32x16_bf16 v[88:103], v[56:59], a[64:67], v[88:103]
    ds_read_b64_tr_b16 v[80:81], v38 offset:2048
    ds_read_b64_tr_b16 v[82:83], v38 offset:2560
    s_waitcnt lgkmcnt(10)
    v_mfma_f32_32x32x16_bf16 v[104:119], v[60:63], a[64:67], v[104:119]
    buffer_load_dwordx4 v15, s[24:27], s61 offen offset:3072 lds
    ds_read_b64_tr_b16 v[84:85], v39 offset:2048
    ds_read_b64_tr_b16 v[86:87], v39 offset:2560
    s_waitcnt lgkmcnt(10)
    v_mfma_f32_32x32x16_bf16 v[120:135], v[64:67], a[64:67], v[120:135]
    ds_read_b64_tr_b16 v[56:57], v36 offset:4096
    ds_read_b64_tr_b16 v[58:59], v36 offset:4608
    s_add_u32 m0, s44, 8192
    s_waitcnt lgkmcnt(10)
    v_mfma_f32_32x32x16_bf16 v[136:151], v[68:71], a[64:67], v[136:151]
    buffer_load_dwordx4 v8, s[20:23], s54 offen lds
    ds_read_b64_tr_b16 v[60:61], v37 offset:4096
    ds_read_b64_tr_b16 v[62:63], v37 offset:4608
    s_waitcnt lgkmcnt(10)
    v_mfma_f32_32x32x16_bf16 v[88:103], v[72:75], a[68:71], v[88:103]
    ds_read_b64_tr_b16 v[64:65], v38 offset:4096
    ds_read_b64_tr_b16 v[66:67], v38 offset:4608
    s_waitcnt lgkmcnt(10)
    v_mfma_f32_32x32x16_bf16 v[104:119], v[76:79], a[68:71], v[104:119]
    buffer_load_dwordx4 v9, s[20:23], s54 offen offset:1024 lds
    ds_read_b64_tr_b16 v[68:69], v39 offset:4096
    ds_read_b64_tr_b16 v[70:71], v39 offset:4608
    s_waitcnt lgkmcnt(10)
    v_mfma_f32_32x32x16_bf16 v[120:135], v[80:83], a[68:71], v[120:135]
    ds_read_b64_tr_b16 v[72:73], v36 offset:6144
    ds_read_b64_tr_b16 v[74:75], v36 offset:6656
    s_waitcnt lgkmcnt(10)
    v_mfma_f32_32x32x16_bf16 v[136:151], v[84:87], a[68:71], v[136:151]
    buffer_load_dwordx4 v10, s[20:23], s54 offen offset:2048 lds
    ds_read_b64_tr_b16 v[76:77], v37 offset:6144
    ds_read_b64_tr_b16 v[78:79], v37 offset:6656
    s_waitcnt lgkmcnt(10)
    v_mfma_f32_32x32x16_bf16 v[88:103], v[56:59], a[72:75], v[88:103]
    ds_read_b64_tr_b16 v[80:81], v38 offset:6144
    ds_read_b64_tr_b16 v[82:83], v38 offset:6656
    s_waitcnt lgkmcnt(10)
    v_mfma_f32_32x32x16_bf16 v[104:119], v[60:63], a[72:75], v[104:119]
    buffer_load_dwordx4 v11, s[20:23], s54 offen offset:3072 lds
    ds_read_b64_tr_b16 v[84:85], v39 offset:6144
    ds_read_b64_tr_b16 v[86:87], v39 offset:6656
    s_waitcnt lgkmcnt(10)
    v_mfma_f32_32x32x16_bf16 v[120:135], v[64:67], a[72:75], v[120:135]
    s_waitcnt vmcnt(4)
    s_barrier
    ds_read_b128 a[80:83], v28 offset:4096
    ds_read_b128 a[84:87], v29 offset:4096
    ds_read_b128 a[88:91], v30 offset:4096
    ds_read_b128 a[92:95], v31 offset:4096
    ds_read_b64_tr_b16 v[56:57], v36 offset:16384
    ds_read_b64_tr_b16 v[58:59], v36 offset:16896
    s_add_u32 m0, s42, 0
    s_waitcnt lgkmcnt(14)
    v_mfma_f32_32x32x16_bf16 v[136:151], v[68:71], a[72:75], v[136:151]
    buffer_load_dwordx4 v12, s[24:27], s62 offen lds
    ds_read_b64_tr_b16 v[60:61], v37 offset:16384
    ds_read_b64_tr_b16 v[62:63], v37 offset:16896
    s_waitcnt lgkmcnt(14)
    v_mfma_f32_32x32x16_bf16 v[88:103], v[72:75], a[76:79], v[88:103]
    ds_read_b64_tr_b16 v[64:65], v38 offset:16384
    ds_read_b64_tr_b16 v[66:67], v38 offset:16896
    s_waitcnt lgkmcnt(14)
    v_mfma_f32_32x32x16_bf16 v[104:119], v[76:79], a[76:79], v[104:119]
    buffer_load_dwordx4 v13, s[24:27], s62 offen offset:1024 lds
    ds_read_b64_tr_b16 v[68:69], v39 offset:16384
    ds_read_b64_tr_b16 v[70:71], v39 offset:16896
    s_waitcnt lgkmcnt(14)
    v_mfma_f32_32x32x16_bf16 v[120:135], v[80:83], a[76:79], v[120:135]
    ds_read_b64_tr_b16 v[72:73], v36 offset:18432
    ds_read_b64_tr_b16 v[74:75], v36 offset:18944
    s_waitcnt lgkmcnt(14)
    v_mfma_f32_32x32x16_bf16 v[136:151], v[84:87], a[76:79], v[136:151]
    buffer_load_dwordx4 v14, s[24:27], s62 offen offset:2048 lds
    ds_read_b64_tr_b16 v[76:77], v37 offset:18432
    ds_read_b64_tr_b16 v[78:79], v37 offset:18944
    s_waitcnt lgkmcnt(10)
    v_mfma_f32_32x32x16_bf16 v[88:103], v[56:59], a[80:83], v[88:103]
    ds_read_b64_tr_b16 v[80:81], v38 offset:18432
    ds_read_b64_tr_b16 v[82:83], v38 offset:18944
    s_waitcnt lgkmcnt(10)
    v_mfma_f32_32x32x16_bf16 v[104:119], v[60:63], a[80:83], v[104:119]
    buffer_load_dwordx4 v15, s[24:27], s62 offen offset:3072 lds
    ds_read_b64_tr_b16 v[84:85], v39 offset:18432
    ds_read_b64_tr_b16 v[86:87], v39 offset:18944
    s_waitcnt lgkmcnt(10)
    v_mfma_f32_32x32x16_bf16 v[120:135], v[64:67], a[80:83], v[120:135]
    ds_read_b64_tr_b16 v[56:57], v36 offset:20480
    ds_read_b64_tr_b16 v[58:59], v36 offset:20992
    s_add_u32 m0, s44, 12288
    s_waitcnt lgkmcnt(10)
    v_mfma_f32_32x32x16_bf16 v[136:151], v[68:71], a[80:83], v[136:151]
    buffer_load_dwordx4 v8, s[20:23], s55 offen lds
    ds_read_b64_tr_b16 v[60:61], v37 offset:20480
    ds_read_b64_tr_b16 v[62:63], v37 offset:20992
    s_waitcnt lgkmcnt(10)
    v_mfma_f32_32x32x16_bf16 v[88:103], v[72:75], a[84:87], v[88:103]
    ds_read_b64_tr_b16 v[64:65], v38 offset:20480
    ds_read_b64_tr_b16 v[66:67], v38 offset:20992
    s_waitcnt lgkmcnt(10)
    v_mfma_f32_32x32x16_bf16 v[104:119], v[76:79], a[84:87], v[104:119]
    buffer_load_dwordx4 v9, s[20:23], s55 offen offset:1024 lds
    ds_read_b64_tr_b16 v[68:69], v39 offset:20480
    ds_read_b64_tr_b16 v[70:71], v39 offset:20992
    s_waitcnt lgkmcnt(10)
    v_mfma_f32_32x32x16_bf16 v[120:135], v[80:83], a[84:87], v[120:135]
    ds_read_b64_tr_b16 v[72:73], v36 offset:22528
    ds_read_b64_tr_b16 v[74:75], v36 offset:23040
    s_waitcnt lgkmcnt(10)
    v_mfma_f32_32x32x16_bf16 v[136:151], v[84:87], a[84:87], v[136:151]
    buffer_load_dwordx4 v10, s[20:23], s55 offen offset:2048 lds
    ds_read_b64_tr_b16 v[76:77], v37 offset:22528
    ds_read_b64_tr_b16 v[78:79], v37 offset:23040
    s_waitcnt lgkmcnt(10)
    v_mfma_f32_32x32x16_bf16 v[88:103], v[56:59], a[88:91], v[88:103]
    ds_read_b64_tr_b16 v[80:81], v38 offset:22528
    ds_read_b64_tr_b16 v[82:83], v38 offset:23040
    s_waitcnt lgkmcnt(10)
    v_mfma_f32_32x32x16_bf16 v[104:119], v[60:63], a[88:91], v[104:119]
    buffer_load_dwordx4 v11, s[20:23], s55 offen offset:3072 lds
    ds_read_b64_tr_b16 v[84:85], v39 offset:22528
    ds_read_b64_tr_b16 v[86:87], v39 offset:23040
    s_waitcnt lgkmcnt(10)
    v_mfma_f32_32x32x16_bf16 v[120:135], v[64:67], a[88:91], v[120:135]
    s_waitcnt vmcnt(4)
    s_barrier
    ds_read_b128 a[96:99], v28 offset:8192
    ds_read_b128 a[100:103], v29 offset:8192
    ds_read_b128 a[104:107], v30 offset:8192
    ds_read_b128 a[108:111], v31 offset:8192
    ds_read_b64_tr_b16 v[56:57], v32 offset:0
    ds_read_b64_tr_b16 v[58:59], v32 offset:512
    s_add_u32 m0, s42, 16384
    s_waitcnt lgkmcnt(14)
    v_mfma_f32_32x32x16_bf16 v[136:151], v[68:71], a[88:91], v[136:151]
    buffer_load_dwordx4 v12, s[24:27], s63 offen lds
    ds_read_b64_tr_b16 v[60:61], v33 offset:0
    ds_read_b64_tr_b16 v[62:63], v33 offset:512
    s_waitcnt lgkmcnt(14)
    v_mfma_f32_32x32x16_bf16 v[88:103], v[72:75], a[92:95], v[88:103]
    ds_read_b64_tr_b16 v[64:65], v34 offset:0
    ds_read_b64_tr_b16 v[66:67], v34 offset:512
    s_waitcnt lgkmcnt(14)
    v_mfma_f32_32x32x16_bf16 v[104:119], v[76:79], a[92:95], v[104:119]
    buffer_load_dwordx4 v13, s[24:27], s63 offen offset:1024 lds
    ds_read_b64_tr_b16 v[68:69], v35 offset:0
    ds_read_b64_tr_b16 v[70:71], v35 offset:512
    s_waitcnt lgkmcnt(14)
    v_mfma_f32_32x32x16_bf16 v[120:135], v[80:83], a[92:95], v[120:135]
    ds_read_b64_tr_b16 v[72:73], v32 offset:2048
    ds_read_b64_tr_b16 v[74:75], v32 offset:2560
    s_waitcnt lgkmcnt(14)
    v_mfma_f32_32x32x16_bf16 v[136:151], v[84:87], a[92:95], v[136:151]
    buffer_load_dwordx4 v14, s[24:27], s63 offen offset:2048 lds
    ds_read_b64_tr_b16 v[76:77], v33 offset:2048
    ds_read_b64_tr_b16 v[78:79], v33 offset:2560
    s_waitcnt lgkmcnt(10)
    v_mfma_f32_32x32x16_bf16 v[88:103], v[56:59], a[96:99], v[88:103]
    ds_read_b64_tr_b16 v[80:81], v34 offset:2048
    ds_read_b64_tr_b16 v[82:83], v34 offset:2560
    s_waitcnt lgkmcnt(10)
    v_mfma_f32_32x32x16_bf16 v[104:119], v[60:63], a[96:99], v[104:119]
    buffer_load_dwordx4 v15, s[24:27], s63 offen offset:3072 lds
    ds_read_b64_tr_b16 v[84:85], v35 offset:2048
    ds_read_b64_tr_b16 v[86:87], v35 offset:2560
    s_waitcnt lgkmcnt(10)
    v_mfma_f32_32x32x16_bf16 v[120:135], v[64:67], a[96:99], v[120:135]
    ds_read_b64_tr_b16 v[56:57], v32 offset:4096
    ds_read_b64_tr_b16 v[58:59], v32 offset:4608
    s_add_u32 m0, s42, 32768
    s_waitcnt lgkmcnt(10)
    v_mfma_f32_32x32x16_bf16 v[136:151], v[68:71], a[96:99], v[136:151]
    buffer_load_dwordx4 v16, s[24:27], s56 offen lds
    ds_read_b64_tr_b16 v[60:61], v33 offset:4096
    ds_read_b64_tr_b16 v[62:63], v33 offset:4608
    s_waitcnt lgkmcnt(10)
    v_mfma_f32_32x32x16_bf16 v[88:103], v[72:75], a[100:103], v[88:103]
    ds_read_b64_tr_b16 v[64:65], v34 offset:4096
    ds_read_b64_tr_b16 v[66:67], v34 offset:4608
    s_waitcnt lgkmcnt(10)
    v_mfma_f32_32x32x16_bf16 v[104:119], v[76:79], a[100:103], v[104:119]
    buffer_load_dwordx4 v17, s[24:27], s56 offen offset:1024 lds
    ds_read_b64_tr_b16 v[68:69], v35 offset:4096
    ds_read_b64_tr_b16 v[70:71], v35 offset:4608
    s_waitcnt lgkmcnt(10)
    v_mfma_f32_32x32x16_bf16 v[120:135], v[80:83], a[100:103], v[120:135]
    ds_read_b64_tr_b16 v[72:73], v32 offset:6144
    ds_read_b64_tr_b16 v[74:75], v32 offset:6656
    s_waitcnt lgkmcnt(10)
    v_mfma_f32_32x32x16_bf16 v[136:151], v[84:87], a[100:103], v[136:151]
    buffer_load_dwordx4 v18, s[24:27], s56 offen offset:2048 lds
    ds_read_b64_tr_b16 v[76:77], v33 offset:6144
    ds_read_b64_tr_b16 v[78:79], v33 offset:6656
    s_waitcnt lgkmcnt(10)
    v_mfma_f32_32x32x16_bf16 v[88:103], v[56:59], a[104:107], v[88:103]
    ds_read_b64_tr_b16 v[80:81], v34 offset:6144
    ds_read_b64_tr_b16 v[82:83], v34 offset:6656
    s_waitcnt lgkmcnt(10)
    v_mfma_f32_32x32x16_bf16 v[104:119], v[60:63], a[104:107], v[104:119]
    buffer_load_dwordx4 v19, s[24:27], s56 offen offset:3072 lds
    ds_read_b64_tr_b16 v[84:85], v35 offset:6144
    ds_read_b64_tr_b16 v[86:87], v35 offset:6656
    s_waitcnt lgkmcnt(10)
    v_mfma_f32_32x32x16_bf16 v[120:135], v[64:67], a[104:107], v[120:135]
    s_waitcnt vmcnt(4)
    s_barrier
    v_add_u32 v42, 1, v42
    ds_read_b128 a[112:115], v28 offset:12288
    ds_read_b128 a[116:119], v29 offset:12288
    ds_read_b128 a[120:123], v30 offset:12288
    ds_read_b128 a[124:127], v31 offset:12288
    ds_read_b64_tr_b16 v[56:57], v32 offset:16384
    ds_read_b64_tr_b16 v[58:59], v32 offset:16896
    s_add_u32 m0, s42, 49152
    s_waitcnt lgkmcnt(14)
    v_mfma_f32_32x32x16_bf16 v[136:151], v[68:71], a[104:107], v[136:151]
    buffer_load_dwordx4 v16, s[24:27], s57 offen lds
    ds_read_b64_tr_b16 v[60:61], v32 offset:18432
    ds_read_b64_tr_b16 v[62:63], v32 offset:18944
    s_waitcnt lgkmcnt(14)
    v_mfma_f32_32x32x16_bf16 v[88:103], v[72:75], a[108:111], v[88:103]
    ds_read_b64_tr_b16 v[64:65], v32 offset:20480
    ds_read_b64_tr_b16 v[66:67], v32 offset:20992
    s_waitcnt lgkmcnt(14)
    v_mfma_f32_32x32x16_bf16 v[104:119], v[76:79], a[108:111], v[104:119]
    buffer_load_dwordx4 v17, s[24:27], s57 offen offset:1024 lds
    ds_read_b64_tr_b16 v[68:69], v32 offset:22528
    ds_read_b64_tr_b16 v[70:71], v32 offset:23040
    s_waitcnt lgkmcnt(14)
    v_mfma_f32_32x32x16_bf16 v[120:135], v[80:83], a[108:111], v[120:135]
    ds_read_b64_tr_b16 v[72:73], v33 offset:16384
    ds_read_b64_tr_b16 v[74:75], v33 offset:16896
    s_waitcnt lgkmcnt(14)
    v_mfma_f32_32x32x16_bf16 v[136:151], v[84:87], a[108:111], v[136:151]
    buffer_load_dwordx4 v18, s[24:27], s57 offen offset:2048 lds
    ds_read_b64_tr_b16 v[76:77], v33 offset:18432
    ds_read_b64_tr_b16 v[78:79], v33 offset:18944
    s_waitcnt lgkmcnt(10)
    v_mfma_f32_32x32x16_bf16 v[88:103], v[56:59], a[112:115], v[88:103]
    ds_read_b64_tr_b16 v[80:81], v33 offset:20480
    ds_read_b64_tr_b16 v[82:83], v33 offset:20992
    s_waitcnt lgkmcnt(10)
    v_mfma_f32_32x32x16_bf16 v[88:103], v[60:63], a[116:119], v[88:103]
    buffer_load_dwordx4 v19, s[24:27], s57 offen offset:3072 lds
    ds_read_b64_tr_b16 v[84:85], v33 offset:22528
    ds_read_b64_tr_b16 v[86:87], v33 offset:23040
    s_waitcnt lgkmcnt(10)
    v_mfma_f32_32x32x16_bf16 v[88:103], v[64:67], a[120:123], v[88:103]
    ds_read_b64_tr_b16 v[56:57], v34 offset:16384
    ds_read_b64_tr_b16 v[58:59], v34 offset:16896
    s_add_u32 m0, s42, 65536
    s_waitcnt lgkmcnt(10)
    v_mfma_f32_32x32x16_bf16 v[88:103], v[68:71], a[124:127], v[88:103]
    buffer_load_dwordx4 v16, s[24:27], s58 offen lds
    ds_read_b64_tr_b16 v[60:61], v34 offset:18432
    ds_read_b64_tr_b16 v[62:63], v34 offset:18944
    s_waitcnt lgkmcnt(10)
    v_mfma_f32_32x32x16_bf16 v[104:119], v[72:75], a[112:115], v[104:119]
    ds_read_b64_tr_b16 v[64:65], v34 offset:20480
    ds_read_b64_tr_b16 v[66:67], v34 offset:20992
    s_waitcnt lgkmcnt(10)
    v_mfma_f32_32x32x16_bf16 v[104:119], v[76:79], a[116:119], v[104:119]
    buffer_load_dwordx4 v17, s[24:27], s58 offen offset:1024 lds
    ds_read_b64_tr_b16 v[68:69], v34 offset:22528
    ds_read_b64_tr_b16 v[70:71], v34 offset:23040
    v_max_f32 v88, 0, v88
    v_max_f32 v89, 0, v89
    s_waitcnt lgkmcnt(10)
    v_mfma_f32_32x32x16_bf16 v[104:119], v[80:83], a[120:123], v[104:119]
    ds_read_b64_tr_b16 v[72:73], v35 offset:16384
    ds_read_b64_tr_b16 v[74:75], v35 offset:16896
    v_max_f32 v90, 0, v90
    v_max_f32 v91, 0, v91
    s_waitcnt lgkmcnt(10)
    v_mfma_f32_32x32x16_bf16 v[104:119], v[84:87], a[124:127], v[104:119]
    buffer_load_dwordx4 v18, s[24:27], s58 offen offset:2048 lds
    ds_read_b64_tr_b16 v[76:77], v35 offset:18432
    ds_read_b64_tr_b16 v[78:79], v35 offset:18944
    v_max_f32 v92, 0, v92
    v_max_f32 v93, 0, v93
    s_waitcnt lgkmcnt(10)
    v_mfma_f32_32x32x16_bf16 v[120:135], v[56:59], a[112:115], v[120:135]
    ds_read_b64_tr_b16 v[80:81], v35 offset:20480
    ds_read_b64_tr_b16 v[82:83], v35 offset:20992
    v_max_f32 v94, 0, v94
    v_max_f32 v95, 0, v95
    s_waitcnt lgkmcnt(10)
    v_mfma_f32_32x32x16_bf16 v[120:135], v[60:63], a[116:119], v[120:135]
    buffer_load_dwordx4 v19, s[24:27], s58 offen offset:3072 lds
    ds_read_b64_tr_b16 v[84:85], v35 offset:22528
    ds_read_b64_tr_b16 v[86:87], v35 offset:23040
    v_pk_mul_f32 v[88:89], v[88:89], v[96:97]
    v_pk_mul_f32 v[90:91], v[90:91], v[98:99]
    s_waitcnt lgkmcnt(10)
    v_mfma_f32_32x32x16_bf16 v[120:135], v[64:67], a[120:123], v[120:135]
    s_waitcnt vmcnt(8)
    s_barrier
    ds_read_b64_tr_b16 v[56:57], v32 offset:32768
    ds_read_b64_tr_b16 v[58:59], v32 offset:33280
    v_pk_mul_f32 v[92:93], v[92:93], v[100:101]
    v_pk_mul_f32 v[94:95], v[94:95], v[102:103]
    s_add_u32 m0, s42, 81920
    s_waitcnt lgkmcnt(10)
    v_mfma_f32_32x32x16_bf16 v[120:135], v[68:71], a[124:127], v[120:135]
    buffer_load_dwordx4 v16, s[24:27], s59 offen lds
    ds_read_b64_tr_b16 v[60:61], v33 offset:32768
    ds_read_b64_tr_b16 v[62:63], v33 offset:33280
    v_cvt_pk_bf16_f32 v48, v88, v89
    v_cvt_pk_bf16_f32 v49, v90, v91
    s_waitcnt lgkmcnt(10)
    v_mfma_f32_32x32x16_bf16 v[136:151], v[72:75], a[112:115], v[136:151]
    ds_read_b64_tr_b16 v[64:65], v34 offset:32768
    ds_read_b64_tr_b16 v[66:67], v34 offset:33280
    v_cvt_pk_bf16_f32 v50, v92, v93
    v_cvt_pk_bf16_f32 v51, v94, v95
    s_waitcnt lgkmcnt(10)
    v_mfma_f32_32x32x16_bf16 v[136:151], v[76:79], a[116:119], v[136:151]
    buffer_load_dwordx4 v17, s[24:27], s59 offen offset:1024 lds
    ds_read_b64_tr_b16 v[68:69], v35 offset:32768
    ds_read_b64_tr_b16 v[70:71], v35 offset:33280
    buffer_store_dwordx4 v[48:51], v46, s[28:31], s45 offen sc1
    v_max_f32 v104, 0, v104
    s_waitcnt lgkmcnt(10)
    v_mfma_f32_32x32x16_bf16 v[136:151], v[80:83], a[120:123], v[136:151]
    ds_read_b64_tr_b16 v[72:73], v32 offset:34816
    ds_read_b64_tr_b16 v[74:75], v32 offset:35328
    v_max_f32 v105, 0, v105
    v_max_f32 v106, 0, v106
    s_waitcnt lgkmcnt(10)
    v_mfma_f32_32x32x16_bf16 v[136:151], v[84:87], a[124:127], v[136:151]
    buffer_load_dwordx4 v18, s[24:27], s59 offen offset:2048 lds
    ds_read_b64_tr_b16 v[76:77], v33 offset:34816
    ds_read_b64_tr_b16 v[78:79], v33 offset:35328
    v_max_f32 v107, 0, v107
    v_max_f32 v108, 0, v108
    s_waitcnt lgkmcnt(10)
    v_mfma_f32_32x32x16_bf16 v[152:167], v[56:59], a[0:3], 0
    ds_read_b64_tr_b16 v[80:81], v34 offset:34816
    ds_read_b64_tr_b16 v[82:83], v34 offset:35328
    v_max_f32 v109, 0, v109
    v_max_f32 v110, 0, v110
    s_waitcnt lgkmcnt(10)
    v_mfma_f32_32x32x16_bf16 v[168:183], v[60:63], a[0:3], 0
    buffer_load_dwordx4 v19, s[24:27], s59 offen offset:3072 lds
    ds_read_b64_tr_b16 v[84:85], v35 offset:34816
    ds_read_b64_tr_b16 v[86:87], v35 offset:35328
    v_max_f32 v111, 0, v111
    v_pk_mul_f32 v[104:105], v[104:105], v[112:113]
    s_waitcnt lgkmcnt(10)
    v_mfma_f32_32x32x16_bf16 v[184:199], v[64:67], a[0:3], 0
    ds_read_b64_tr_b16 v[56:57], v32 offset:36864
    ds_read_b64_tr_b16 v[58:59], v32 offset:37376
    v_pk_mul_f32 v[106:107], v[106:107], v[114:115]
    v_pk_mul_f32 v[108:109], v[108:109], v[116:117]
    s_add_u32 m0, s42, 0
    s_waitcnt lgkmcnt(10)
    v_mfma_f32_32x32x16_bf16 v[200:215], v[68:71], a[0:3], 0
    buffer_load_dwordx4 v16, s[24:27], s60 offen lds
    ds_read_b64_tr_b16 v[60:61], v33 offset:36864
    ds_read_b64_tr_b16 v[62:63], v33 offset:37376
    v_pk_mul_f32 v[110:111], v[110:111], v[118:119]
    v_cvt_pk_bf16_f32 v52, v104, v105
    s_waitcnt lgkmcnt(10)
    v_mfma_f32_32x32x16_bf16 v[152:167], v[72:75], a[4:7], v[152:167]
    ds_read_b64_tr_b16 v[64:65], v34 offset:36864
    ds_read_b64_tr_b16 v[66:67], v34 offset:37376
    v_cvt_pk_bf16_f32 v53, v106, v107
    v_cvt_pk_bf16_f32 v54, v108, v109
    s_waitcnt lgkmcnt(10)
    v_mfma_f32_32x32x16_bf16 v[168:183], v[76:79], a[4:7], v[168:183]
    buffer_load_dwordx4 v17, s[24:27], s60 offen offset:1024 lds
    ds_read_b64_tr_b16 v[68:69], v35 offset:36864
    ds_read_b64_tr_b16 v[70:71], v35 offset:37376
    v_cvt_pk_bf16_f32 v55, v110, v111
    buffer_store_dwordx4 v[52:55], v46, s[28:31], s45 offen offset:1024 sc1
    s_waitcnt lgkmcnt(10)
    v_mfma_f32_32x32x16_bf16 v[184:199], v[80:83], a[4:7], v[184:199]
    ds_read_b64_tr_b16 v[72:73], v32 offset:38912
    ds_read_b64_tr_b16 v[74:75], v32 offset:39424
    v_max_f32 v120, 0, v120
    v_max_f32 v121, 0, v121
    s_waitcnt lgkmcnt(10)
    v_mfma_f32_32x32x16_bf16 v[200:215], v[84:87], a[4:7], v[200:215]
    buffer_load_dwordx4 v18, s[24:27], s60 offen offset:2048 lds
    ds_read_b64_tr_b16 v[76:77], v33 offset:38912
    ds_read_b64_tr_b16 v[78:79], v33 offset:39424
    v_max_f32 v122, 0, v122
    v_max_f32 v123, 0, v123
    s_waitcnt lgkmcnt(10)
    v_mfma_f32_32x32x16_bf16 v[152:167], v[56:59], a[8:11], v[152:167]
    ds_read_b64_tr_b16 v[80:81], v34 offset:38912
    ds_read_b64_tr_b16 v[82:83], v34 offset:39424
    v_max_f32 v124, 0, v124
    v_max_f32 v125, 0, v125
    s_waitcnt lgkmcnt(10)
    v_mfma_f32_32x32x16_bf16 v[168:183], v[60:63], a[8:11], v[168:183]
    buffer_load_dwordx4 v19, s[24:27], s60 offen offset:3072 lds
    ds_read_b64_tr_b16 v[84:85], v35 offset:38912
    ds_read_b64_tr_b16 v[86:87], v35 offset:39424
    v_max_f32 v126, 0, v126
    v_max_f32 v127, 0, v127
    s_waitcnt lgkmcnt(10)
    v_mfma_f32_32x32x16_bf16 v[184:199], v[64:67], a[8:11], v[184:199]
    s_waitcnt vmcnt(14)
    s_barrier
    ds_read_b64_tr_b16 v[56:57], v32 offset:49152
    ds_read_b64_tr_b16 v[58:59], v32 offset:49664
    v_pk_mul_f32 v[120:121], v[120:121], v[128:129]
    v_pk_mul_f32 v[122:123], v[122:123], v[130:131]
    s_add_u32 m0, s42, 16384
    s_waitcnt lgkmcnt(10)
    v_mfma_f32_32x32x16_bf16 v[200:215], v[68:71], a[8:11], v[200:215]
    buffer_load_dwordx4 v16, s[24:27], s61 offen lds
    ds_read_b64_tr_b16 v[60:61], v33 offset:49152
    ds_read_b64_tr_b16 v[62:63], v33 offset:49664
    v_pk_mul_f32 v[124:125], v[124:125], v[132:133]
    v_pk_mul_f32 v[126:127], v[126:127], v[134:135]
    s_waitcnt lgkmcnt(10)
    v_mfma_f32_32x32x16_bf16 v[152:167], v[72:75], a[12:15], v[152:167]
    ds_read_b64_tr_b16 v[64:65], v34 offset:49152
    ds_read_b64_tr_b16 v[66:67], v34 offset:49664
    v_cvt_pk_bf16_f32 v48, v120, v121
    v_cvt_pk_bf16_f32 v49, v122, v123
    s_waitcnt lgkmcnt(10)
    v_mfma_f32_32x32x16_bf16 v[168:183], v[76:79], a[12:15], v[168:183]
    buffer_load_dwordx4 v17, s[24:27], s61 offen offset:1024 lds
    ds_read_b64_tr_b16 v[68:69], v35 offset:49152
    ds_read_b64_tr_b16 v[70:71], v35 offset:49664
    v_cvt_pk_bf16_f32 v50, v124, v125
    v_cvt_pk_bf16_f32 v51, v126, v127
    s_waitcnt lgkmcnt(10)
    v_mfma_f32_32x32x16_bf16 v[184:199], v[80:83], a[12:15], v[184:199]
    ds_read_b64_tr_b16 v[72:73], v32 offset:51200
    ds_read_b64_tr_b16 v[74:75], v32 offset:51712
    buffer_store_dwordx4 v[48:51], v46, s[28:31], s45 offen offset:2048 sc1
    v_max_f32 v136, 0, v136
    s_waitcnt lgkmcnt(10)
    v_mfma_f32_32x32x16_bf16 v[200:215], v[84:87], a[12:15], v[200:215]
    buffer_load_dwordx4 v18, s[24:27], s61 offen offset:2048 lds
    ds_read_b64_tr_b16 v[76:77], v33 offset:51200
    ds_read_b64_tr_b16 v[78:79], v33 offset:51712
    v_max_f32 v137, 0, v137
    v_max_f32 v138, 0, v138
    s_waitcnt lgkmcnt(10)
    v_mfma_f32_32x32x16_bf16 v[152:167], v[56:59], a[16:19], v[152:167]
    ds_read_b64_tr_b16 v[80:81], v34 offset:51200
    ds_read_b64_tr_b16 v[82:83], v34 offset:51712
    v_max_f32 v139, 0, v139
    v_max_f32 v140, 0, v140
    s_waitcnt lgkmcnt(10)
    v_mfma_f32_32x32x16_bf16 v[168:183], v[60:63], a[16:19], v[168:183]
    buffer_load_dwordx4 v19, s[24:27], s61 offen offset:3072 lds
    ds_read_b64_tr_b16 v[84:85], v35 offset:51200
    ds_read_b64_tr_b16 v[86:87], v35 offset:51712
    v_max_f32 v141, 0, v141
    v_max_f32 v142, 0, v142
    s_waitcnt lgkmcnt(10)
    v_mfma_f32_32x32x16_bf16 v[184:199], v[64:67], a[16:19], v[184:199]
    ds_read_b64_tr_b16 v[56:57], v32 offset:53248
    ds_read_b64_tr_b16 v[58:59], v32 offset:53760
    v_max_f32 v143, 0, v143
    v_pk_mul_f32 v[136:137], v[136:137], v[144:145]
    s_add_u32 m0, s44, 0
    s_waitcnt lgkmcnt(10)
    v_mfma_f32_32x32x16_bf16 v[200:215], v[68:71], a[16:19], v[200:215]
    s_lshl_b32 s82, s64, 7
    buffer_load_dwordx4 v20, s[32:35], s82 offen lds
    ds_read_b64_tr_b16 v[60:61], v33 offset:53248
    ds_read_b64_tr_b16 v[62:63], v33 offset:53760
    v_pk_mul_f32 v[138:139], v[138:139], v[146:147]
    v_pk_mul_f32 v[140:141], v[140:141], v[148:149]
    s_waitcnt lgkmcnt(10)
    v_mfma_f32_32x32x16_bf16 v[152:167], v[72:75], a[20:23], v[152:167]
    ds_read_b64_tr_b16 v[64:65], v34 offset:53248
    ds_read_b64_tr_b16 v[66:67], v34 offset:53760
    v_pk_mul_f32 v[142:143], v[142:143], v[150:151]
    v_cvt_pk_bf16_f32 v52, v136, v137
    s_waitcnt lgkmcnt(10)
    v_mfma_f32_32x32x16_bf16 v[168:183], v[76:79], a[20:23], v[168:183]
    buffer_load_dwordx4 v21, s[32:35], s82 offen offset:1024 lds
    ds_read_b64_tr_b16 v[68:69], v35 offset:53248
    ds_read_b64_tr_b16 v[70:71], v35 offset:53760
    v_cvt_pk_bf16_f32 v53, v138, v139
    v_cvt_pk_bf16_f32 v54, v140, v141
    s_waitcnt lgkmcnt(10)
    v_mfma_f32_32x32x16_bf16 v[184:199], v[80:83], a[20:23], v[184:199]
    ds_read_b64_tr_b16 v[72:73], v32 offset:55296
    ds_read_b64_tr_b16 v[74:75], v32 offset:55808
    v_cvt_pk_bf16_f32 v55, v142, v143
    buffer_store_dwordx4 v[52:55], v46, s[28:31], s45 offen offset:3072 sc1
    s_add_u32 m0, s44, 2048
    s_waitcnt lgkmcnt(10)
    v_mfma_f32_32x32x16_bf16 v[200:215], v[84:87], a[20:23], v[200:215]
    s_lshl_b32 s82, s65, 7
    buffer_load_dwordx4 v20, s[32:35], s82 offen lds
    ds_read_b64_tr_b16 v[76:77], v33 offset:55296
    ds_read_b64_tr_b16 v[78:79], v33 offset:55808
    s_waitcnt lgkmcnt(10)
    v_mfma_f32_32x32x16_bf16 v[152:167], v[56:59], a[24:27], v[152:167]
    ds_read_b64_tr_b16 v[80:81], v34 offset:55296
    ds_read_b64_tr_b16 v[82:83], v34 offset:55808
    s_waitcnt lgkmcnt(10)
    v_mfma_f32_32x32x16_bf16 v[168:183], v[60:63], a[24:27], v[168:183]
    buffer_load_dwordx4 v21, s[32:35], s82 offen offset:1024 lds
    ds_read_b64_tr_b16 v[84:85], v35 offset:55296
    ds_read_b64_tr_b16 v[86:87], v35 offset:55808
    s_waitcnt lgkmcnt(10)
    v_mfma_f32_32x32x16_bf16 v[184:199], v[64:67], a[24:27], v[184:199]
    s_waitcnt vmcnt(20)
    s_barrier
    ds_read_b64_tr_b16 v[56:57], v36 offset:0
    ds_read_b64_tr_b16 v[58:59], v36 offset:512
    s_add_u32 m0, s42, 32768
    s_waitcnt lgkmcnt(10)
    v_mfma_f32_32x32x16_bf16 v[200:215], v[68:71], a[24:27], v[200:215]
    buffer_load_dwordx4 v16, s[24:27], s62 offen lds
    ds_read_b64_tr_b16 v[60:61], v37 offset:0
    ds_read_b64_tr_b16 v[62:63], v37 offset:512
    s_waitcnt lgkmcnt(10)
    v_mfma_f32_32x32x16_bf16 v[152:167], v[72:75], a[28:31], v[152:167]
    ds_read_b64_tr_b16 v[64:65], v38 offset:0
    ds_read_b64_tr_b16 v[66:67], v38 offset:512
    s_waitcnt lgkmcnt(10)
    v_mfma_f32_32x32x16_bf16 v[168:183], v[76:79], a[28:31], v[168:183]
    buffer_load_dwordx4 v17, s[24:27], s62 offen offset:1024 lds
    ds_read_b64_tr_b16 v[68:69], v39 offset:0
    ds_read_b64_tr_b16 v[70:71], v39 offset:512
    s_waitcnt lgkmcnt(10)
    v_mfma_f32_32x32x16_bf16 v[184:199], v[80:83], a[28:31], v[184:199]
    ds_read_b64_tr_b16 v[72:73], v36 offset:2048
    ds_read_b64_tr_b16 v[74:75], v36 offset:2560
    s_waitcnt lgkmcnt(10)
    v_mfma_f32_32x32x16_bf16 v[200:215], v[84:87], a[28:31], v[200:215]
    buffer_load_dwordx4 v18, s[24:27], s62 offen offset:2048 lds
    ds_read_b64_tr_b16 v[76:77], v37 offset:2048
    ds_read_b64_tr_b16 v[78:79], v37 offset:2560
    s_waitcnt lgkmcnt(10)
    v_mfma_f32_32x32x16_bf16 v[152:167], v[56:59], a[32:35], v[152:167]
    ds_read_b64_tr_b16 v[80:81], v38 offset:2048
    ds_read_b64_tr_b16 v[82:83], v38 offset:2560
    s_waitcnt lgkmcnt(10)
    v_mfma_f32_32x32x16_bf16 v[168:183], v[60:63], a[32:35], v[168:183]
    buffer_load_dwordx4 v19, s[24:27], s62 offen offset:3072 lds
    ds_read_b64_tr_b16 v[84:85], v39 offset:2048
    ds_read_b64_tr_b16 v[86:87], v39 offset:2560
    s_waitcnt lgkmcnt(10)
    v_mfma_f32_32x32x16_bf16 v[184:199], v[64:67], a[32:35], v[184:199]
    ds_read_b64_tr_b16 v[56:57], v36 offset:4096
    ds_read_b64_tr_b16 v[58:59], v36 offset:4608
    s_add_u32 m0, s44, 4096
    s_waitcnt lgkmcnt(10)
    v_mfma_f32_32x32x16_bf16 v[200:215], v[68:71], a[32:35], v[200:215]
    s_lshl_b32 s82, s66, 7
    buffer_load_dwordx4 v20, s[32:35], s82 offen lds
    ds_read_b64_tr_b16 v[60:61], v37 offset:4096
    ds_read_b64_tr_b16 v[62:63], v37 offset:4608
    s_waitcnt lgkmcnt(10)
    v_mfma_f32_32x32x16_bf16 v[152:167], v[72:75], a[36:39], v[152:167]
    ds_read_b64_tr_b16 v[64:65], v38 offset:4096
    ds_read_b64_tr_b16 v[66:67], v38 offset:4608
    s_waitcnt lgkmcnt(10)
    v_mfma_f32_32x32x16_bf16 v[168:183], v[76:79], a[36:39], v[168:183]
    buffer_load_dwordx4 v21, s[32:35], s82 offen offset:1024 lds
    ds_read_b64_tr_b16 v[68:69], v39 offset:4096
    ds_read_b64_tr_b16 v[70:71], v39 offset:4608
    s_waitcnt lgkmcnt(10)
    v_mfma_f32_32x32x16_bf16 v[184:199], v[80:83], a[36:39], v[184:199]
    ds_read_b64_tr_b16 v[72:73], v36 offset:6144
    ds_read_b64_tr_b16 v[74:75], v36 offset:6656
    s_add_u32 m0, s44, 6144
    s_waitcnt lgkmcnt(10)
    v_mfma_f32_32x32x16_bf16 v[200:215], v[84:87], a[36:39], v[200:215]
    s_lshl_b32 s82, s67, 7
    buffer_load_dwordx4 v20, s[32:35], s82 offen lds
    ds_read_b64_tr_b16 v[76:77], v37 offset:6144
    ds_read_b64_tr_b16 v[78:79], v37 offset:6656
    s_waitcnt lgkmcnt(10)
    v_mfma_f32_32x32x16_bf16 v[152:167], v[56:59], a[40:43], v[152:167]
    ds_read_b64_tr_b16 v[80:81], v38 offset:6144
    ds_read_b64_tr_b16 v[82:83], v38 offset:6656
    s_waitcnt vmcnt(10)
    ds_read_b64_tr_b16 a[128:129], v40 offset:0
    ds_read_b64_tr_b16 a[130:131], v40 offset:1024
    ds_read_b64_tr_b16 a[132:133], v41 offset:0
    ds_read_b64_tr_b16 a[134:135], v41 offset:1024
    s_waitcnt lgkmcnt(14)
    v_mfma_f32_32x32x16_bf16 v[168:183], v[60:63], a[40:43], v[168:183]
    buffer_load_dwordx4 v21, s[32:35], s82 offen offset:1024 lds
    ds_read_b64_tr_b16 v[84:85], v39 offset:6144
    ds_read_b64_tr_b16 v[86:87], v39 offset:6656
    s_waitcnt lgkmcnt(14)
    v_mfma_f32_32x32x16_bf16 v[184:199], v[64:67], a[40:43], v[184:199]
    s_barrier
    ds_read_b64_tr_b16 v[56:57], v36 offset:16384
    ds_read_b64_tr_b16 v[58:59], v36 offset:16896
    s_add_u32 m0, s42, 49152
    s_waitcnt lgkmcnt(14)
    v_mfma_f32_32x32x16_bf16 v[200:215], v[68:71], a[40:43], v[200:215]
    buffer_load_dwordx4 v16, s[24:27], s63 offen lds
    ds_read_b64_tr_b16 v[60:61], v37 offset:16384
    ds_read_b64_tr_b16 v[62:63], v37 offset:16896
    s_waitcnt lgkmcnt(14)
    v_mfma_f32_32x32x16_bf16 v[152:167], v[72:75], a[44:47], v[152:167]
    ds_read_b64_tr_b16 v[64:65], v38 offset:16384
    ds_read_b64_tr_b16 v[66:67], v38 offset:16896
    s_waitcnt lgkmcnt(14)
    v_mfma_f32_32x32x16_bf16 v[168:183], v[76:79], a[44:47], v[168:183]
    buffer_load_dwordx4 v17, s[24:27], s63 offen offset:1024 lds
    ds_read_b64_tr_b16 v[68:69], v39 offset:16384
    ds_read_b64_tr_b16 v[70:71], v39 offset:16896
    s_waitcnt lgkmcnt(14)
    v_mfma_f32_32x32x16_bf16 v[184:199], v[80:83], a[44:47], v[184:199]
    ds_read_b64_tr_b16 v[72:73], v36 offset:18432
    ds_read_b64_tr_b16 v[74:75], v36 offset:18944
    s_waitcnt vmcnt(10)
    ds_read_b64_tr_b16 a[136:137], v40 offset:2048
    ds_read_b64_tr_b16 a[138:139], v40 offset:3072
    ds_read_b64_tr_b16 a[140:141], v41 offset:2048
    ds_read_b64_tr_b16 a[142:143], v41 offset:3072
    s_waitcnt lgkmcnt(14)
    v_mfma_f32_32x32x16_bf16 v[200:215], v[84:87], a[44:47], v[200:215]
    buffer_load_dwordx4 v18, s[24:27], s63 offen offset:2048 lds
    ds_read_b64_tr_b16 v[76:77], v37 offset:18432
    ds_read_b64_tr_b16 v[78:79], v37 offset:18944
    s_waitcnt lgkmcnt(14)
    v_mfma_f32_32x32x16_bf16 v[152:167], v[56:59], a[48:51], v[152:167]
    ds_read_b64_tr_b16 v[80:81], v38 offset:18432
    ds_read_b64_tr_b16 v[82:83], v38 offset:18944
    s_waitcnt lgkmcnt(14)
    v_mfma_f32_32x32x16_bf16 v[168:183], v[60:63], a[48:51], v[168:183]
    buffer_load_dwordx4 v19, s[24:27], s63 offen offset:3072 lds
    ds_read_b64_tr_b16 v[84:85], v39 offset:18432
    ds_read_b64_tr_b16 v[86:87], v39 offset:18944
    s_waitcnt lgkmcnt(14)
    v_mfma_f32_32x32x16_bf16 v[184:199], v[64:67], a[48:51], v[184:199]
    ds_read_b64_tr_b16 v[56:57], v36 offset:20480
    ds_read_b64_tr_b16 v[58:59], v36 offset:20992
    s_add_u32 m0, s44, 8192
    s_waitcnt lgkmcnt(14)
    v_mfma_f32_32x32x16_bf16 v[200:215], v[68:71], a[48:51], v[200:215]
    s_lshl_b32 s82, s68, 7
    buffer_load_dwordx4 v20, s[32:35], s82 offen lds
    ds_read_b64_tr_b16 v[60:61], v37 offset:20480
    ds_read_b64_tr_b16 v[62:63], v37 offset:20992
    s_waitcnt lgkmcnt(14)
    v_mfma_f32_32x32x16_bf16 v[152:167], v[72:75], a[52:55], v[152:167]
    ds_read_b64_tr_b16 v[64:65], v38 offset:20480
    ds_read_b64_tr_b16 v[66:67], v38 offset:20992
    s_waitcnt lgkmcnt(10)
    v_mfma_f32_32x32x16_bf16 v[168:183], v[76:79], a[52:55], v[168:183]
    buffer_load_dwordx4 v21, s[32:35], s82 offen offset:1024 lds
    ds_read_b64_tr_b16 v[68:69], v39 offset:20480
    ds_read_b64_tr_b16 v[70:71], v39 offset:20992
    s_waitcnt lgkmcnt(10)
    v_mfma_f32_32x32x16_bf16 v[184:199], v[80:83], a[52:55], v[184:199]
    ds_read_b64_tr_b16 v[72:73], v36 offset:22528
    ds_read_b64_tr_b16 v[74:75], v36 offset:23040
    s_add_u32 m0, s44, 10240
    s_waitcnt lgkmcnt(10)
    v_mfma_f32_32x32x16_bf16 v[200:215], v[84:87], a[52:55], v[200:215]
    s_lshl_b32 s82, s69, 7
    buffer_load_dwordx4 v20, s[32:35], s82 offen lds
    ds_read_b64_tr_b16 v[76:77], v37 offset:22528
    ds_read_b64_tr_b16 v[78:79], v37 offset:23040
    s_waitcnt lgkmcnt(10)
    v_mfma_f32_32x32x16_bf16 v[152:167], v[56:59], a[56:59], v[152:167]
    ds_read_b64_tr_b16 v[80:81], v38 offset:22528
    ds_read_b64_tr_b16 v[82:83], v38 offset:23040
    s_waitcnt lgkmcnt(10)
    v_mfma_f32_32x32x16_bf16 v[168:183], v[60:63], a[56:59], v[168:183]
    buffer_load_dwordx4 v21, s[32:35], s82 offen offset:1024 lds
    ds_read_b64_tr_b16 v[84:85], v39 offset:22528
    ds_read_b64_tr_b16 v[86:87], v39 offset:23040
    s_waitcnt lgkmcnt(10)
    v_mfma_f32_32x32x16_bf16 v[184:199], v[64:67], a[56:59], v[184:199]
    s_barrier
    ds_read_b64_tr_b16 v[56:57], v32 offset:0
    ds_read_b64_tr_b16 v[58:59], v32 offset:512
    s_waitcnt vmcnt(10)
    ds_read_b64_tr_b16 a[144:145], v40 offset:4096
    ds_read_b64_tr_b16 a[146:147], v40 offset:5120
    ds_read_b64_tr_b16 a[148:149], v41 offset:4096
    ds_read_b64_tr_b16 a[150:151], v41 offset:5120
    s_add_u32 m0, s44, 12288
    s_waitcnt lgkmcnt(14)
    v_mfma_f32_32x32x16_bf16 v[200:215], v[68:71], a[56:59], v[200:215]
    s_lshl_b32 s82, s70, 7
    buffer_load_dwordx4 v20, s[32:35], s82 offen lds
    ds_read_b64_tr_b16 v[60:61], v33 offset:0
    ds_read_b64_tr_b16 v[62:63], v33 offset:512
    s_waitcnt lgkmcnt(14)
    v_mfma_f32_32x32x16_bf16 v[152:167], v[72:75], a[60:63], v[152:167]
    ds_read_b64_tr_b16 v[64:65], v34 offset:0
    ds_read_b64_tr_b16 v[66:67], v34 offset:512
    s_waitcnt lgkmcnt(14)
    v_mfma_f32_32x32x16_bf16 v[168:183], v[76:79], a[60:63], v[168:183]
    buffer_load_dwordx4 v21, s[32:35], s82 offen offset:1024 lds
    ds_read_b64_tr_b16 v[68:69], v35 offset:0
    ds_read_b64_tr_b16 v[70:71], v35 offset:512
    s_mov_b64 exec, 1
    buffer_store_dword v42, v45, s[28:31], s47 offen sc1
    s_mov_b64 exec, -1
    s_waitcnt lgkmcnt(14)
    v_mfma_f32_32x32x16_bf16 v[184:199], v[80:83], a[60:63], v[184:199]
    ds_read_b64_tr_b16 v[72:73], v32 offset:2048
    ds_read_b64_tr_b16 v[74:75], v32 offset:2560
    s_waitcnt vmcnt(11)
    ds_read_b64_tr_b16 a[152:153], v40 offset:6144
    ds_read_b64_tr_b16 a[154:155], v40 offset:7168
    ds_read_b64_tr_b16 a[156:157], v41 offset:6144
    ds_read_b64_tr_b16 a[158:159], v41 offset:7168
    s_add_u32 m0, s44, 14336
    s_waitcnt lgkmcnt(15)
    v_mfma_f32_32x32x16_bf16 v[200:215], v[84:87], a[60:63], v[200:215]
    s_lshl_b32 s82, s71, 7
    buffer_load_dwordx4 v20, s[32:35], s82 offen lds
    ds_read_b64_tr_b16 v[76:77], v33 offset:2048
    ds_read_b64_tr_b16 v[78:79], v33 offset:2560
    v_mfma_f32_32x32x16_bf16 v[152:167], v[56:59], a[64:67], v[152:167]
    ds_read_b64_tr_b16 v[80:81], v34 offset:2048
    ds_read_b64_tr_b16 v[82:83], v34 offset:2560
    s_waitcnt lgkmcnt(14)
    v_mfma_f32_32x32x16_bf16 v[168:183], v[60:63], a[64:67], v[168:183]
    buffer_load_dwordx4 v21, s[32:35], s82 offen offset:1024 lds
    ds_read_b64_tr_b16 v[84:85], v35 offset:2048
    ds_read_b64_tr_b16 v[86:87], v35 offset:2560
    s_waitcnt lgkmcnt(14)
    v_mfma_f32_32x32x16_bf16 v[184:199], v[64:67], a[64:67], v[184:199]
    ds_read_b64_tr_b16 v[56:57], v32 offset:4096
    ds_read_b64_tr_b16 v[58:59], v32 offset:4608
    s_add_u32 m0, s44, 0
    s_waitcnt lgkmcnt(14)
    v_mfma_f32_32x32x16_bf16 v[200:215], v[68:71], a[64:67], v[200:215]
    s_lshl_b32 s82, s72, 7
    buffer_load_dwordx4 v20, s[32:35], s82 offen lds
    ds_read_b64_tr_b16 v[60:61], v33 offset:4096
    ds_read_b64_tr_b16 v[62:63], v33 offset:4608
    s_waitcnt lgkmcnt(14)
    v_mfma_f32_32x32x16_bf16 v[152:167], v[72:75], a[68:71], v[152:167]
    ds_read_b64_tr_b16 v[64:65], v34 offset:4096
    ds_read_b64_tr_b16 v[66:67], v34 offset:4608
    s_waitcnt lgkmcnt(10)
    v_mfma_f32_32x32x16_bf16 v[168:183], v[76:79], a[68:71], v[168:183]
    buffer_load_dwordx4 v21, s[32:35], s82 offen offset:1024 lds
    ds_read_b64_tr_b16 v[68:69], v35 offset:4096
    ds_read_b64_tr_b16 v[70:71], v35 offset:4608
    s_waitcnt lgkmcnt(10)
    v_mfma_f32_32x32x16_bf16 v[184:199], v[80:83], a[68:71], v[184:199]
    ds_read_b64_tr_b16 v[72:73], v32 offset:6144
    ds_read_b64_tr_b16 v[74:75], v32 offset:6656
    s_add_u32 m0, s44, 2048
    s_waitcnt lgkmcnt(10)
    v_mfma_f32_32x32x16_bf16 v[200:215], v[84:87], a[68:71], v[200:215]
    s_lshl_b32 s82, s73, 7
    buffer_load_dwordx4 v20, s[32:35], s82 offen lds
    ds_read_b64_tr_b16 v[76:77], v33 offset:6144
    ds_read_b64_tr_b16 v[78:79], v33 offset:6656
    s_waitcnt lgkmcnt(10)
    v_mfma_f32_32x32x16_bf16 v[152:167], v[56:59], a[72:75], v[152:167]
    ds_read_b64_tr_b16 v[80:81], v34 offset:6144
    ds_read_b64_tr_b16 v[82:83], v34 offset:6656
    s_waitcnt lgkmcnt(10)
    v_mfma_f32_32x32x16_bf16 v[168:183], v[60:63], a[72:75], v[168:183]
    buffer_load_dwordx4 v21, s[32:35], s82 offen offset:1024 lds
    ds_read_b64_tr_b16 v[84:85], v35 offset:6144
    ds_read_b64_tr_b16 v[86:87], v35 offset:6656
    s_waitcnt lgkmcnt(10)
    v_mfma_f32_32x32x16_bf16 v[184:199], v[64:67], a[72:75], v[184:199]
    s_barrier
    ds_read_b64_tr_b16 v[56:57], v32 offset:16384
    ds_read_b64_tr_b16 v[58:59], v32 offset:16896
    s_waitcnt vmcnt(11)
    ds_read_b64_tr_b16 a[160:161], v40 offset:8192
    ds_read_b64_tr_b16 a[162:163], v40 offset:9216
    ds_read_b64_tr_b16 a[164:165], v41 offset:8192
    ds_read_b64_tr_b16 a[166:167], v41 offset:9216
    s_add_u32 m0, s44, 4096
    s_waitcnt lgkmcnt(14)
    v_mfma_f32_32x32x16_bf16 v[200:215], v[68:71], a[72:75], v[200:215]
    s_lshl_b32 s82, s74, 7
    buffer_load_dwordx4 v20, s[32:35], s82 offen lds
    ds_read_b64_tr_b16 v[60:61], v33 offset:16384
    ds_read_b64_tr_b16 v[62:63], v33 offset:16896
    s_waitcnt lgkmcnt(14)
    v_mfma_f32_32x32x16_bf16 v[152:167], v[72:75], a[76:79], v[152:167]
    ds_read_b64_tr_b16 v[64:65], v34 offset:16384
    ds_read_b64_tr_b16 v[66:67], v34 offset:16896
    s_waitcnt lgkmcnt(14)
    v_mfma_f32_32x32x16_bf16 v[168:183], v[76:79], a[76:79], v[168:183]
    buffer_load_dwordx4 v21, s[32:35], s82 offen offset:1024 lds
    ds_read_b64_tr_b16 v[68:69], v35 offset:16384
    ds_read_b64_tr_b16 v[70:71], v35 offset:16896
    s_waitcnt lgkmcnt(14)
    v_mfma_f32_32x32x16_bf16 v[184:199], v[80:83], a[76:79], v[184:199]
    ds_read_b64_tr_b16 v[72:73], v32 offset:18432
    ds_read_b64_tr_b16 v[74:75], v32 offset:18944
    s_waitcnt vmcnt(11)
    ds_read_b64_tr_b16 a[168:169], v40 offset:10240
    ds_read_b64_tr_b16 a[170:171], v40 offset:11264
    ds_read_b64_tr_b16 a[172:173], v41 offset:10240
    ds_read_b64_tr_b16 a[174:175], v41 offset:11264
    s_add_u32 m0, s44, 6144
    s_waitcnt lgkmcnt(15)
    v_mfma_f32_32x32x16_bf16 v[200:215], v[84:87], a[76:79], v[200:215]
    s_lshl_b32 s82, s75, 7
    buffer_load_dwordx4 v20, s[32:35], s82 offen lds
    ds_read_b64_tr_b16 v[76:77], v33 offset:18432
    ds_read_b64_tr_b16 v[78:79], v33 offset:18944
    v_mfma_f32_32x32x16_bf16 v[152:167], v[56:59], a[80:83], v[152:167]
    ds_read_b64_tr_b16 v[80:81], v34 offset:18432
    ds_read_b64_tr_b16 v[82:83], v34 offset:18944
    s_waitcnt lgkmcnt(14)
    v_mfma_f32_32x32x16_bf16 v[168:183], v[60:63], a[80:83], v[168:183]
    buffer_load_dwordx4 v21, s[32:35], s82 offen offset:1024 lds
    ds_read_b64_tr_b16 v[84:85], v35 offset:18432
    ds_read_b64_tr_b16 v[86:87], v35 offset:18944
    s_waitcnt lgkmcnt(14)
    v_mfma_f32_32x32x16_bf16 v[184:199], v[64:67], a[80:83], v[184:199]
    ds_read_b64_tr_b16 v[56:57], v32 offset:20480
    ds_read_b64_tr_b16 v[58:59], v32 offset:20992
    s_waitcnt vmcnt(11)
    ds_read_b64_tr_b16 a[176:177], v40 offset:12288
    ds_read_b64_tr_b16 a[178:179], v40 offset:13312
    ds_read_b64_tr_b16 a[180:181], v41 offset:12288
    ds_read_b64_tr_b16 a[182:183], v41 offset:13312
    s_add_u32 m0, s44, 8192
    s_waitcnt lgkmcnt(15)
    v_mfma_f32_32x32x16_bf16 v[200:215], v[68:71], a[80:83], v[200:215]
    s_lshl_b32 s82, s76, 7
    buffer_load_dwordx4 v20, s[32:35], s82 offen lds
    ds_read_b64_tr_b16 v[60:61], v33 offset:20480
    ds_read_b64_tr_b16 v[62:63], v33 offset:20992
    v_mfma_f32_32x32x16_bf16 v[152:167], v[72:75], a[84:87], v[152:167]
    ds_read_b64_tr_b16 v[64:65], v34 offset:20480
    ds_read_b64_tr_b16 v[66:67], v34 offset:20992
    s_waitcnt lgkmcnt(14)
    v_mfma_f32_32x32x16_bf16 v[168:183], v[76:79], a[84:87], v[168:183]
    buffer_load_dwordx4 v21, s[32:35], s82 offen offset:1024 lds
    ds_read_b64_tr_b16 v[68:69], v35 offset:20480
    ds_read_b64_tr_b16 v[70:71], v35 offset:20992
    s_waitcnt lgkmcnt(14)
    v_mfma_f32_32x32x16_bf16 v[184:199], v[80:83], a[84:87], v[184:199]
    ds_read_b64_tr_b16 v[72:73], v32 offset:22528
    ds_read_b64_tr_b16 v[74:75], v32 offset:23040
    s_waitcnt vmcnt(10)
    ds_read_b64_tr_b16 a[184:185], v40 offset:14336
    ds_read_b64_tr_b16 a[186:187], v40 offset:15360
    ds_read_b64_tr_b16 a[188:189], v41 offset:14336
    ds_read_b64_tr_b16 a[190:191], v41 offset:15360
    s_add_u32 m0, s44, 10240
    s_waitcnt lgkmcnt(15)
    v_mfma_f32_32x32x16_bf16 v[200:215], v[84:87], a[84:87], v[200:215]
    s_lshl_b32 s82, s77, 7
    buffer_load_dwordx4 v20, s[32:35], s82 offen lds
    ds_read_b64_tr_b16 v[76:77], v33 offset:22528
    ds_read_b64_tr_b16 v[78:79], v33 offset:23040
    v_mfma_f32_32x32x16_bf16 v[152:167], v[56:59], a[88:91], v[152:167]
    ds_read_b64_tr_b16 v[80:81], v34 offset:22528
    ds_read_b64_tr_b16 v[82:83], v34 offset:23040
    s_waitcnt lgkmcnt(14)
    v_mfma_f32_32x32x16_bf16 v[168:183], v[60:63], a[88:91], v[168:183]
    buffer_load_dwordx4 v21, s[32:35], s82 offen offset:1024 lds
    ds_read_b64_tr_b16 v[84:85], v35 offset:22528
    ds_read_b64_tr_b16 v[86:87], v35 offset:23040
    s_waitcnt lgkmcnt(14)
    v_mfma_f32_32x32x16_bf16 v[184:199], v[64:67], a[88:91], v[184:199]
    s_barrier
    ds_read_b64_tr_b16 v[56:57], v32 offset:32768
    ds_read_b64_tr_b16 v[58:59], v32 offset:33280
    s_waitcnt vmcnt(10)
    ds_read_b64_tr_b16 a[192:193], v40 offset:0
    ds_read_b64_tr_b16 a[194:195], v40 offset:1024
    ds_read_b64_tr_b16 a[196:197], v41 offset:0
    ds_read_b64_tr_b16 a[198:199], v41 offset:1024
    s_add_u32 m0, s44, 12288
    s_waitcnt lgkmcnt(15)
    v_mfma_f32_32x32x16_bf16 v[200:215], v[68:71], a[88:91], v[200:215]
    s_lshl_b32 s82, s64, 7
    buffer_load_dwordx4 v22, s[32:35], s82 offen lds
    ds_read_b64_tr_b16 v[60:61], v33 offset:32768
    ds_read_b64_tr_b16 v[62:63], v33 offset:33280
    v_mfma_f32_32x32x16_bf16 v[152:167], v[72:75], a[92:95], v[152:167]
    ds_read_b64_tr_b16 v[64:65], v34 offset:32768
    ds_read_b64_tr_b16 v[66:67], v34 offset:33280
    s_waitcnt lgkmcnt(14)
    v_mfma_f32_32x32x16_bf16 v[168:183], v[76:79], a[92:95], v[168:183]
    buffer_load_dwordx4 v23, s[32:35], s82 offen offset:1024 lds
    ds_read_b64_tr_b16 v[68:69], v35 offset:32768
    ds_read_b64_tr_b16 v[70:71], v35 offset:33280
    s_waitcnt lgkmcnt(14)
    v_mfma_f32_32x32x16_bf16 v[184:199], v[80:83], a[92:95], v[184:199]
    ds_read_b64_tr_b16 v[72:73], v32 offset:34816
    ds_read_b64_tr_b16 v[74:75], v32 offset:35328
    s_waitcnt vmcnt(10)
    ds_read_b64_tr_b16 a[200:201], v40 offset:2048
    ds_read_b64_tr_b16 a[202:203], v40 offset:3072
    ds_read_b64_tr_b16 a[204:205], v41 offset:2048
    ds_read_b64_tr_b16 a[206:207], v41 offset:3072
    s_add_u32 m0, s44, 14336
    s_waitcnt lgkmcnt(15)
    v_mfma_f32_32x32x16_bf16 v[200:215], v[84:87], a[92:95], v[200:215]
    s_lshl_b32 s82, s65, 7
    buffer_load_dwordx4 v22, s[32:35], s82 offen lds
    ds_read_b64_tr_b16 v[76:77], v33 offset:34816
    ds_read_b64_tr_b16 v[78:79], v33 offset:35328
    v_mfma_f32_32x32x16_bf16 v[152:167], v[56:59], a[96:99], v[152:167]
    ds_read_b64_tr_b16 v[80:81], v34 offset:34816
    ds_read_b64_tr_b16 v[82:83], v34 offset:35328
    s_waitcnt lgkmcnt(14)
    v_mfma_f32_32x32x16_bf16 v[168:183], v[60:63], a[96:99], v[168:183]
    buffer_load_dwordx4 v23, s[32:35], s82 offen offset:1024 lds
    ds_read_b64_tr_b16 v[84:85], v35 offset:34816
    ds_read_b64_tr_b16 v[86:87], v35 offset:35328
    s_waitcnt lgkmcnt(14)
    v_mfma_f32_32x32x16_bf16 v[184:199], v[64:67], a[96:99], v[184:199]
    ds_read_b64_tr_b16 v[56:57], v32 offset:36864
    ds_read_b64_tr_b16 v[58:59], v32 offset:37376
    s_waitcnt vmcnt(10)
    ds_read_b64_tr_b16 a[208:209], v40 offset:4096
    ds_read_b64_tr_b16 a[210:211], v40 offset:5120
    ds_read_b64_tr_b16 a[212:213], v41 offset:4096
    ds_read_b64_tr_b16 a[214:215], v41 offset:5120
    s_add_u32 m0, s44, 0
    s_waitcnt lgkmcnt(15)
    v_mfma_f32_32x32x16_bf16 v[200:215], v[68:71], a[96:99], v[200:215]
    s_lshl_b32 s82, s66, 7
    buffer_load_dwordx4 v22, s[32:35], s82 offen lds
    ds_read_b64_tr_b16 v[60:61], v33 offset:36864
    ds_read_b64_tr_b16 v[62:63], v33 offset:37376
    v_mfma_f32_32x32x16_bf16 v[152:167], v[72:75], a[100:103], v[152:167]
    ds_read_b64_tr_b16 v[64:65], v34 offset:36864
    ds_read_b64_tr_b16 v[66:67], v34 offset:37376
    s_waitcnt lgkmcnt(14)
    v_mfma_f32_32x32x16_bf16 v[168:183], v[76:79], a[100:103], v[168:183]
    buffer_load_dwordx4 v23, s[32:35], s82 offen offset:1024 lds
    ds_read_b64_tr_b16 v[68:69], v35 offset:36864
    ds_read_b64_tr_b16 v[70:71], v35 offset:37376
    s_waitcnt lgkmcnt(14)
    v_mfma_f32_32x32x16_bf16 v[184:199], v[80:83], a[100:103], v[184:199]
    ds_read_b64_tr_b16 v[72:73], v32 offset:38912
    ds_read_b64_tr_b16 v[74:75], v32 offset:39424
    s_waitcnt vmcnt(10)
    ds_read_b64_tr_b16 a[216:217], v40 offset:6144
    ds_read_b64_tr_b16 a[218:219], v40 offset:7168
    ds_read_b64_tr_b16 a[220:221], v41 offset:6144
    ds_read_b64_tr_b16 a[222:223], v41 offset:7168
    s_add_u32 m0, s44, 2048
    s_waitcnt lgkmcnt(15)
    v_mfma_f32_32x32x16_bf16 v[200:215], v[84:87], a[100:103], v[200:215]
    s_lshl_b32 s82, s67, 7
    buffer_load_dwordx4 v22, s[32:35], s82 offen lds
    ds_read_b64_tr_b16 v[76:77], v33 offset:38912
    ds_read_b64_tr_b16 v[78:79], v33 offset:39424
    v_mfma_f32_32x32x16_bf16 v[152:167], v[56:59], a[104:107], v[152:167]
    ds_read_b64_tr_b16 v[80:81], v34 offset:38912
    ds_read_b64_tr_b16 v[82:83], v34 offset:39424
    s_waitcnt lgkmcnt(14)
    v_mfma_f32_32x32x16_bf16 v[168:183], v[60:63], a[104:107], v[168:183]
    buffer_load_dwordx4 v23, s[32:35], s82 offen offset:1024 lds
    ds_read_b64_tr_b16 v[84:85], v35 offset:38912
    ds_read_b64_tr_b16 v[86:87], v35 offset:39424
    s_waitcnt lgkmcnt(14)
    v_mfma_f32_32x32x16_bf16 v[184:199], v[64:67], a[104:107], v[184:199]
    s_barrier
    ds_read_b64_tr_b16 v[56:57], v32 offset:49152
    ds_read_b64_tr_b16 v[58:59], v32 offset:49664
    s_waitcnt vmcnt(10)
    ds_read_b64_tr_b16 a[224:225], v40 offset:8192
    ds_read_b64_tr_b16 a[226:227], v40 offset:9216
    ds_read_b64_tr_b16 a[228:229], v41 offset:8192
    ds_read_b64_tr_b16 a[230:231], v41 offset:9216
    s_add_u32 m0, s44, 4096
    s_waitcnt lgkmcnt(15)
    v_mfma_f32_32x32x16_bf16 v[200:215], v[68:71], a[104:107], v[200:215]
    s_lshl_b32 s82, s68, 7
    buffer_load_dwordx4 v22, s[32:35], s82 offen lds
    ds_read_b64_tr_b16 v[60:61], v32 offset:51200
    ds_read_b64_tr_b16 v[62:63], v32 offset:51712
    v_mfma_f32_32x32x16_bf16 v[152:167], v[72:75], a[108:111], v[152:167]
    ds_read_b64_tr_b16 v[64:65], v32 offset:53248
    ds_read_b64_tr_b16 v[66:67], v32 offset:53760
    s_waitcnt lgkmcnt(14)
    v_mfma_f32_32x32x16_bf16 v[168:183], v[76:79], a[108:111], v[168:183]
    buffer_load_dwordx4 v23, s[32:35], s82 offen offset:1024 lds
    ds_read_b64_tr_b16 v[68:69], v32 offset:55296
    ds_read_b64_tr_b16 v[70:71], v32 offset:55808
    s_waitcnt lgkmcnt(14)
    v_mfma_f32_32x32x16_bf16 v[184:199], v[80:83], a[108:111], v[184:199]
    ds_read_b64_tr_b16 v[72:73], v33 offset:49152
    ds_read_b64_tr_b16 v[74:75], v33 offset:49664
    s_waitcnt vmcnt(10)
    ds_read_b64_tr_b16 a[232:233], v40 offset:10240
    ds_read_b64_tr_b16 a[234:235], v40 offset:11264
    ds_read_b64_tr_b16 a[236:237], v41 offset:10240
    ds_read_b64_tr_b16 a[238:239], v41 offset:11264
    s_add_u32 m0, s44, 6144
    s_waitcnt lgkmcnt(15)
    v_mfma_f32_32x32x16_bf16 v[200:215], v[84:87], a[108:111], v[200:215]
    s_lshl_b32 s82, s69, 7
    buffer_load_dwordx4 v22, s[32:35], s82 offen lds
    ds_read_b64_tr_b16 v[76:77], v33 offset:51200
    ds_read_b64_tr_b16 v[78:79], v33 offset:51712
    v_mfma_f32_32x32x16_bf16 v[152:167], v[56:59], a[112:115], v[152:167]
    ds_read_b64_tr_b16 v[80:81], v33 offset:53248
    ds_read_b64_tr_b16 v[82:83], v33 offset:53760
    s_waitcnt lgkmcnt(14)
    v_mfma_f32_32x32x16_bf16 v[152:167], v[60:63], a[116:119], v[152:167]
    ds_read_b64_tr_b16 v[84:85], v33 offset:55296
    ds_read_b64_tr_b16 v[86:87], v33 offset:55808
    s_waitcnt lgkmcnt(14)
    v_mfma_f32_32x32x16_bf16 v[152:167], v[64:67], a[120:123], v[152:167]
    ds_read_b64_tr_b16 v[56:57], v34 offset:49152
    ds_read_b64_tr_b16 v[58:59], v34 offset:49664
    s_waitcnt lgkmcnt(14)
    v_mfma_f32_32x32x16_bf16 v[152:167], v[68:71], a[124:127], v[152:167]
    ds_read_b64_tr_b16 v[60:61], v34 offset:51200
    ds_read_b64_tr_b16 v[62:63], v34 offset:51712
    s_waitcnt lgkmcnt(14)
    v_mfma_f32_32x32x16_bf16 v[168:183], v[72:75], a[112:115], v[168:183]
    ds_read_b64_tr_b16 v[64:65], v34 offset:53248
    ds_read_b64_tr_b16 v[66:67], v34 offset:53760
    s_waitcnt lgkmcnt(10)
    v_mfma_f32_32x32x16_bf16 v[168:183], v[76:79], a[116:119], v[168:183]
    ds_read_b64_tr_b16 v[68:69], v34 offset:55296
    ds_read_b64_tr_b16 v[70:71], v34 offset:55808
    s_nop 1
    v_max_f32 v152, 0, v152
    v_max_f32 v153, 0, v153
    v_max_f32 v154, 0, v154
    s_waitcnt lgkmcnt(10)
    v_mfma_f32_32x32x16_bf16 v[168:183], v[80:83], a[120:123], v[168:183]
    ds_read_b64_tr_b16 v[72:73], v35 offset:49152
    ds_read_b64_tr_b16 v[74:75], v35 offset:49664
    v_max_f32 v155, 0, v155
    v_max_f32 v156, 0, v156
    v_max_f32 v157, 0, v157
    s_waitcnt lgkmcnt(10)
    v_mfma_f32_32x32x16_bf16 v[168:183], v[84:87], a[124:127], v[168:183]
    ds_read_b64_tr_b16 v[76:77], v35 offset:51200
    ds_read_b64_tr_b16 v[78:79], v35 offset:51712
    v_max_f32 v158, 0, v158
    v_max_f32 v159, 0, v159
    v_pk_mul_f32 v[152:153], v[152:153], v[160:161]
    s_waitcnt lgkmcnt(10)
    v_mfma_f32_32x32x16_bf16 v[184:199], v[56:59], a[112:115], v[184:199]
    ds_read_b64_tr_b16 v[80:81], v35 offset:53248
    ds_read_b64_tr_b16 v[82:83], v35 offset:53760
    v_pk_mul_f32 v[154:155], v[154:155], v[162:163]
    v_pk_mul_f32 v[156:157], v[156:157], v[164:165]
    v_pk_mul_f32 v[158:159], v[158:159], v[166:167]
    s_waitcnt lgkmcnt(10)
    v_mfma_f32_32x32x16_bf16 v[184:199], v[60:63], a[116:119], v[184:199]
    ds_read_b64_tr_b16 v[84:85], v35 offset:55296
    ds_read_b64_tr_b16 v[86:87], v35 offset:55808
    v_cvt_pk_bf16_f32 v48, v152, v153
    v_cvt_pk_bf16_f32 v49, v154, v155
    v_cvt_pk_bf16_f32 v50, v156, v157
    s_waitcnt lgkmcnt(10)
    v_mfma_f32_32x32x16_bf16 v[184:199], v[64:67], a[120:123], v[184:199]
    v_cvt_pk_bf16_f32 v51, v158, v159
    buffer_store_dwordx4 v[48:51], v46, s[28:31], s46 offen sc1
    v_max_f32 v168, 0, v168
    s_waitcnt lgkmcnt(8)
    v_mfma_f32_32x32x16_bf16 v[184:199], v[68:71], a[124:127], v[184:199]
    s_waitcnt vmcnt(10)
    ds_read_b64_tr_b16 a[240:241], v40 offset:12288
    ds_read_b64_tr_b16 a[242:243], v40 offset:13312
    ds_read_b64_tr_b16 a[244:245], v41 offset:12288
    ds_read_b64_tr_b16 a[246:247], v41 offset:13312
    v_max_f32 v169, 0, v169
    v_max_f32 v170, 0, v170
    v_max_f32 v171, 0, v171
    s_waitcnt lgkmcnt(10)
    v_mfma_f32_32x32x16_bf16 v[200:215], v[72:75], a[112:115], v[200:215]
    v_max_f32 v172, 0, v172
    v_max_f32 v173, 0, v173
    v_max_f32 v174, 0, v174
    s_waitcnt lgkmcnt(8)
    v_mfma_f32_32x32x16_bf16 v[200:215], v[76:79], a[116:119], v[200:215]
    v_max_f32 v175, 0, v175
    v_pk_mul_f32 v[168:169], v[168:169], v[176:177]
    v_pk_mul_f32 v[170:171], v[170:171], v[178:179]
    s_waitcnt lgkmcnt(6)
    v_mfma_f32_32x32x16_bf16 v[200:215], v[80:83], a[120:123], v[200:215]
    v_pk_mul_f32 v[172:173], v[172:173], v[180:181]
    v_pk_mul_f32 v[174:175], v[174:175], v[182:183]
    v_cvt_pk_bf16_f32 v52, v168, v169
    s_waitcnt lgkmcnt(4)
    v_mfma_f32_32x32x16_bf16 v[200:215], v[84:87], a[124:127], v[200:215]
    v_cvt_pk_bf16_f32 v53, v170, v171
    v_cvt_pk_bf16_f32 v54, v172, v173
    v_cvt_pk_bf16_f32 v55, v174, v175
    buffer_store_dwordx4 v[52:55], v46, s[28:31], s46 offen offset:1024 sc1
    v_max_f32 v184, 0, v184
    v_max_f32 v185, 0, v185
    v_max_f32 v186, 0, v186
    v_max_f32 v187, 0, v187
    v_max_f32 v188, 0, v188
    v_max_f32 v189, 0, v189
    v_max_f32 v190, 0, v190
    v_max_f32 v191, 0, v191
    v_pk_mul_f32 v[184:185], v[184:185], v[192:193]
    v_pk_mul_f32 v[186:187], v[186:187], v[194:195]
    v_pk_mul_f32 v[188:189], v[188:189], v[196:197]
    buffer_load_dwordx4 v23, s[32:35], s82 offen offset:1024 lds
    v_pk_mul_f32 v[190:191], v[190:191], v[198:199]
    v_cvt_pk_bf16_f32 v48, v184, v185
    v_cvt_pk_bf16_f32 v49, v186, v187
    v_cvt_pk_bf16_f32 v50, v188, v189
    v_cvt_pk_bf16_f32 v51, v190, v191
    buffer_store_dwordx4 v[48:51], v46, s[28:31], s46 offen offset:2048 sc1
    v_max_f32 v200, 0, v200
    v_max_f32 v201, 0, v201
    v_max_f32 v202, 0, v202
    v_max_f32 v203, 0, v203
    v_max_f32 v204, 0, v204
    v_max_f32 v205, 0, v205
    s_add_u32 m0, s44, 8192
    s_lshl_b32 s82, s70, 7
    buffer_load_dwordx4 v22, s[32:35], s82 offen lds
    v_max_f32 v206, 0, v206
    v_max_f32 v207, 0, v207
    v_pk_mul_f32 v[200:201], v[200:201], v[208:209]
    v_pk_mul_f32 v[202:203], v[202:203], v[210:211]
    v_pk_mul_f32 v[204:205], v[204:205], v[212:213]
    v_pk_mul_f32 v[206:207], v[206:207], v[214:215]
    v_cvt_pk_bf16_f32 v52, v200, v201
    v_cvt_pk_bf16_f32 v53, v202, v203
    v_cvt_pk_bf16_f32 v54, v204, v205
    v_cvt_pk_bf16_f32 v55, v206, v207
    buffer_store_dwordx4 v[52:55], v46, s[28:31], s46 offen offset:3072 sc1
    s_barrier
    buffer_load_dwordx4 v23, s[32:35], s82 offen offset:1024 lds
    s_waitcnt vmcnt(14)
    ds_read_b64_tr_b16 a[248:249], v40 offset:14336
    ds_read_b64_tr_b16 a[250:251], v40 offset:15360
    ds_read_b64_tr_b16 a[252:253], v41 offset:14336
    ds_read_b64_tr_b16 a[254:255], v41 offset:15360
    s_add_u32 m0, s44, 10240
    s_lshl_b32 s82, s71, 7
    buffer_load_dwordx4 v22, s[32:35], s82 offen lds
    s_waitcnt vmcnt(13)
    ds_read_b64_tr_b16 v[216:217], v40 offset:0
    ds_read_b64_tr_b16 v[218:219], v40 offset:1024
    ds_read_b64_tr_b16 v[220:221], v41 offset:0
    ds_read_b64_tr_b16 v[222:223], v41 offset:1024
    buffer_load_dwordx4 v23, s[32:35], s82 offen offset:1024 lds
    s_waitcnt vmcnt(12)
    ds_read_b64_tr_b16 v[224:225], v40 offset:2048
    ds_read_b64_tr_b16 v[226:227], v40 offset:3072
    ds_read_b64_tr_b16 v[228:229], v41 offset:2048
    ds_read_b64_tr_b16 v[230:231], v41 offset:3072
    s_add_u32 m0, s44, 12288
    s_waitcnt lgkmcnt(12)
    s_lshl_b32 s82, s72, 7
    buffer_load_dwordx4 v22, s[32:35], s82 offen lds
    s_waitcnt vmcnt(11)
    ds_read_b64_tr_b16 v[232:233], v40 offset:4096
    ds_read_b64_tr_b16 v[234:235], v40 offset:5120
    ds_read_b64_tr_b16 v[236:237], v41 offset:4096
    ds_read_b64_tr_b16 v[238:239], v41 offset:5120
    buffer_load_dwordx4 v23, s[32:35], s82 offen offset:1024 lds
    s_add_u32 m0, s44, 14336
    s_waitcnt lgkmcnt(12)
    s_lshl_b32 s82, s73, 7
    buffer_load_dwordx4 v22, s[32:35], s82 offen lds
    buffer_load_dwordx4 v23, s[32:35], s82 offen offset:1024 lds
    s_waitcnt vmcnt(10)
    ds_read_b64_tr_b16 v[240:241], v40 offset:6144
    ds_read_b64_tr_b16 v[242:243], v40 offset:7168
    ds_read_b64_tr_b16 v[244:245], v41 offset:6144
    ds_read_b64_tr_b16 v[246:247], v41 offset:7168
    s_add_u32 m0, s44, 0
    s_waitcnt lgkmcnt(12)
    s_lshl_b32 s82, s74, 7
    buffer_load_dwordx4 v22, s[32:35], s82 offen lds
    s_waitcnt vmcnt(8)
    s_mov_b64 exec, 1
    buffer_store_dword v42, v45, s[28:31], s47 offen offset:128 sc1
    s_mov_b64 exec, -1
    buffer_load_dwordx4 v23, s[32:35], s82 offen offset:1024 lds
    buffer_load_dword v43, v44, s[28:31], 0 offen sc1
    s_add_u32 m0, s44, 2048
    s_waitcnt lgkmcnt(8)
    s_lshl_b32 s82, s75, 7
    buffer_load_dwordx4 v22, s[32:35], s82 offen lds
    s_waitcnt vmcnt(11)
    ds_read_b64_tr_b16 v[248:249], v40 offset:8192
    ds_read_b64_tr_b16 v[250:251], v40 offset:9216
    ds_read_b64_tr_b16 v[252:253], v41 offset:8192
    ds_read_b64_tr_b16 v[254:255], v41 offset:9216
    buffer_load_dwordx4 v23, s[32:35], s82 offen offset:1024 lds
    s_add_u32 m0, s44, 4096
    s_waitcnt lgkmcnt(8)
    s_lshl_b32 s82, s76, 7
    buffer_load_dwordx4 v22, s[32:35], s82 offen lds
    buffer_load_dwordx4 v23, s[32:35], s82 offen offset:1024 lds
    s_add_u32 m0, s44, 6144
    s_waitcnt lgkmcnt(4)
    s_lshl_b32 s82, s77, 7
    buffer_load_dwordx4 v22, s[32:35], s82 offen lds
    buffer_load_dwordx4 v23, s[32:35], s82 offen offset:1024 lds
    s_waitcnt vmcnt(6)
    v_cmp_ne_u32 vcc, v43, v42
    s_nop 1
    s_and_b32 s78, vcc_lo, 0x3fffffff
    s_cbranch_scc0 L_fm02_ok
    s_mov_b32 s81, 0
L_fm02_spin:
    buffer_load_dword v43, v44, s[28:31], 0 offen sc1
    s_add_u32 s81, s81, 1
    s_cmp_gt_u32 s81, 50000
    s_cbranch_scc1 L_fm02_ok
    s_waitcnt vmcnt(0)
    v_cmp_ne_u32 vcc, v43, v42
    s_nop 1
    s_and_b32 s78, vcc_lo, 0x3fffffff
    s_cbranch_scc1 L_fm02_spin
L_fm02_ok:
    s_mul_i32 s83, s64, 8
    buffer_load_dwordx4 a[0:3], v24, s[28:31], s83 offen sc1
    buffer_load_dwordx4 a[4:7], v25, s[28:31], s83 offen sc1
    s_mul_i32 s83, s65, 8
    buffer_load_dwordx4 a[8:11], v24, s[28:31], s83 offen sc1
    buffer_load_dwordx4 a[12:15], v25, s[28:31], s83 offen sc1
    s_mul_i32 s83, s66, 8
    buffer_load_dwordx4 a[16:19], v24, s[28:31], s83 offen sc1
    buffer_load_dwordx4 a[20:23], v25, s[28:31], s83 offen sc1
    s_mul_i32 s83, s67, 8
    buffer_load_dwordx4 a[24:27], v24, s[28:31], s83 offen sc1
    buffer_load_dwordx4 a[28:31], v25, s[28:31], s83 offen sc1
    s_mul_i32 s83, s68, 8
    buffer_load_dwordx4 a[32:35], v24, s[28:31], s83 offen sc1
    s_waitcnt vmcnt(8)
    v_mfma_f32_32x32x16_bf16 v[88:103], a[128:131], a[0:3], 0
    v_mfma_f32_32x32x16_bf16 v[120:135], a[132:135], a[0:3], 0
    buffer_load_dwordx4 a[36:39], v25, s[28:31], s83 offen sc1
    s_waitcnt vmcnt(8)
    v_mfma_f32_32x32x16_bf16 v[104:119], a[128:131], a[4:7], 0
    v_mfma_f32_32x32x16_bf16 v[136:151], a[132:135], a[4:7], 0
    s_mul_i32 s83, s69, 8
    buffer_load_dwordx4 a[40:43], v24, s[28:31], s83 offen sc1
    ds_read_b64_tr_b16 a[128:129], v40 offset:10240
    ds_read_b64_tr_b16 a[130:131], v40 offset:11264
    ds_read_b64_tr_b16 a[132:133], v41 offset:10240
    ds_read_b64_tr_b16 a[134:135], v41 offset:11264
    s_waitcnt vmcnt(8)
    v_mfma_f32_32x32x16_bf16 v[88:103], a[136:139], a[8:11], v[88:103]
    v_mfma_f32_32x32x16_bf16 v[120:135], a[140:143], a[8:11], v[120:135]
    buffer_load_dwordx4 a[44:47], v25, s[28:31], s83 offen sc1
    s_waitcnt vmcnt(8)
    v_mfma_f32_32x32x16_bf16 v[104:119], a[136:139], a[12:15], v[104:119]
    v_mfma_f32_32x32x16_bf16 v[136:151], a[140:143], a[12:15], v[136:151]
    s_mul_i32 s83, s70, 8
    buffer_load_dwordx4 a[48:51], v24, s[28:31], s83 offen sc1
    ds_read_b64_tr_b16 a[136:137], v40 offset:12288
    ds_read_b64_tr_b16 a[138:139], v40 offset:13312
    ds_read_b64_tr_b16 a[140:141], v41 offset:12288
    ds_read_b64_tr_b16 a[142:143], v41 offset:13312
    s_waitcnt vmcnt(8)
    v_mfma_f32_32x32x16_bf16 v[88:103], a[144:147], a[16:19], v[88:103]
    v_mfma_f32_32x32x16_bf16 v[120:135], a[148:151], a[16:19], v[120:135]
    buffer_load_dwordx4 a[52:55], v25, s[28:31], s83 offen sc1
    s_waitcnt vmcnt(8)
    v_mfma_f32_32x32x16_bf16 v[104:119], a[144:147], a[20:23], v[104:119]
    v_mfma_f32_32x32x16_bf16 v[136:151], a[148:151], a[20:23], v[136:151]
    s_mul_i32 s83, s71, 8
    buffer_load_dwordx4 a[56:59], v24, s[28:31], s83 offen sc1
    ds_read_b64_tr_b16 a[144:145], v40 offset:14336
    ds_read_b64_tr_b16 a[146:147], v40 offset:15360
    ds_read_b64_tr_b16 a[148:149], v41 offset:14336
    ds_read_b64_tr_b16 a[150:151], v41 offset:15360
    s_waitcnt vmcnt(8)
    v_mfma_f32_32x32x16_bf16 v[88:103], a[152:155], a[24:27], v[88:103]
    v_mfma_f32_32x32x16_bf16 v[120:135], a[156:159], a[24:27], v[120:135]
    buffer_load_dwordx4 a[60:63], v25, s[28:31], s83 offen sc1
    s_waitcnt vmcnt(8)
    v_mfma_f32_32x32x16_bf16 v[104:119], a[152:155], a[28:31], v[104:119]
    v_mfma_f32_32x32x16_bf16 v[136:151], a[156:159], a[28:31], v[136:151]
    s_mul_i32 s83, s72, 8
    buffer_load_dwordx4 a[64:67], v24, s[28:31], s83 offen sc1
    ds_read_b64_tr_b16 a[152:153], v40 offset:0
    ds_read_b64_tr_b16 a[154:155], v40 offset:1024
    ds_read_b64_tr_b16 a[156:157], v41 offset:0
    ds_read_b64_tr_b16 a[158:159], v41 offset:1024
    s_waitcnt vmcnt(8)
    v_mfma_f32_32x32x16_bf16 v[88:103], a[160:163], a[32:35], v[88:103]
    v_mfma_f32_32x32x16_bf16 v[120:135], a[164:167], a[32:35], v[120:135]
    buffer_load_dwordx4 a[68:71], v25, s[28:31], s83 offen sc1
    s_waitcnt vmcnt(8)
    v_mfma_f32_32x32x16_bf16 v[104:119], a[160:163], a[36:39], v[104:119]
    v_mfma_f32_32x32x16_bf16 v[136:151], a[164:167], a[36:39], v[136:151]
    s_mul_i32 s83, s73, 8
    buffer_load_dwordx4 a[72:75], v24, s[28:31], s83 offen sc1
    ds_read_b64_tr_b16 a[160:161], v40 offset:2048
    ds_read_b64_tr_b16 a[162:163], v40 offset:3072
    ds_read_b64_tr_b16 a[164:165], v41 offset:2048
    ds_read_b64_tr_b16 a[166:167], v41 offset:3072
    s_waitcnt vmcnt(8)
    v_mfma_f32_32x32x16_bf16 v[88:103], a[168:171], a[40:43], v[88:103]
    v_mfma_f32_32x32x16_bf16 v[120:135], a[172:175], a[40:43], v[120:135]
    buffer_load_dwordx4 a[76:79], v25, s[28:31], s83 offen sc1
    s_waitcnt vmcnt(8)
    v_mfma_f32_32x32x16_bf16 v[104:119], a[168:171], a[44:47], v[104:119]
    v_mfma_f32_32x32x16_bf16 v[136:151], a[172:175], a[44:47], v[136:151]
    s_mul_i32 s83, s74, 8
    buffer_load_dwordx4 a[80:83], v24, s[28:31], s83 offen sc1
    ds_read_b64_tr_b16 a[168:169], v40 offset:4096
    ds_read_b64_tr_b16 a[170:171], v40 offset:5120
    ds_read_b64_tr_b16 a[172:173], v41 offset:4096
    ds_read_b64_tr_b16 a[174:175], v41 offset:5120
    s_waitcnt vmcnt(8)
    v_mfma_f32_32x32x16_bf16 v[88:103], a[176:179], a[48:51], v[88:103]
    v_mfma_f32_32x32x16_bf16 v[120:135], a[180:183], a[48:51], v[120:135]
    buffer_load_dwordx4 a[84:87], v25, s[28:31], s83 offen sc1
    s_waitcnt vmcnt(8)
    v_mfma_f32_32x32x16_bf16 v[104:119], a[176:179], a[52:55], v[104:119]
    v_mfma_f32_32x32x16_bf16 v[136:151], a[180:183], a[52:55], v[136:151]
    buffer_load_dword v43, v44, s[28:31], 0 offen offset:128 sc1
    ds_read_b64_tr_b16 a[176:177], v40 offset:6144
    ds_read_b64_tr_b16 a[178:179], v40 offset:7168
    ds_read_b64_tr_b16 a[180:181], v41 offset:6144
    ds_read_b64_tr_b16 a[182:183], v41 offset:7168
    s_waitcnt vmcnt(8)
    v_mfma_f32_32x32x16_bf16 v[88:103], a[184:187], a[56:59], v[88:103]
    v_mfma_f32_32x32x16_bf16 v[120:135], a[188:191], a[56:59], v[120:135]
    s_mul_i32 s83, s75, 8
    buffer_load_dwordx4 a[88:91], v24, s[28:31], s83 offen sc1
    s_waitcnt vmcnt(8)
    v_mfma_f32_32x32x16_bf16 v[104:119], a[184:187], a[60:63], v[104:119]
    v_mfma_f32_32x32x16_bf16 v[136:151], a[188:191], a[60:63], v[136:151]
    buffer_load_dwordx4 a[92:95], v25, s[28:31], s83 offen sc1
    s_waitcnt vmcnt(8)
    v_mfma_f32_32x32x16_bf16 v[88:103], a[192:195], a[64:67], v[88:103]
    v_mfma_f32_32x32x16_bf16 v[120:135], a[196:199], a[64:67], v[120:135]
    s_mul_i32 s83, s76, 8
    buffer_load_dwordx4 a[96:99], v24, s[28:31], s83 offen sc1
    s_waitcnt vmcnt(8)
    v_mfma_f32_32x32x16_bf16 v[104:119], a[192:195], a[68:71], v[104:119]
    v_mfma_f32_32x32x16_bf16 v[136:151], a[196:199], a[68:71], v[136:151]
    buffer_load_dwordx4 a[100:103], v25, s[28:31], s83 offen sc1
    s_waitcnt vmcnt(8)
    v_mfma_f32_32x32x16_bf16 v[88:103], a[200:203], a[72:75], v[88:103]
    v_mfma_f32_32x32x16_bf16 v[120:135], a[204:207], a[72:75], v[120:135]
    s_mul_i32 s83, s77, 8
    buffer_load_dwordx4 a[104:107], v24, s[28:31], s83 offen sc1
    s_waitcnt vmcnt(8)
    v_mfma_f32_32x32x16_bf16 v[104:119], a[200:203], a[76:79], v[104:119]
    v_mfma_f32_32x32x16_bf16 v[136:151], a[204:207], a[76:79], v[136:151]
    buffer_load_dwordx4 a[108:111], v25, s[28:31], s83 offen sc1
    s_waitcnt vmcnt(8)
    v_mfma_f32_32x32x16_bf16 v[88:103], a[208:211], a[80:83], v[88:103]
    v_mfma_f32_32x32x16_bf16 v[120:135], a[212:215], a[80:83], v[120:135]
    s_waitcnt vmcnt(6)
    v_cmp_ne_u32 vcc, v43, v42
    s_nop 1
    s_and_b32 s78, vcc_lo, s18
    s_cbranch_scc0 L_fm10_ok
    s_mov_b32 s81, 0
L_fm10_spin:
    buffer_load_dword v43, v44, s[28:31], 0 offen offset:128 sc1
    s_add_u32 s81, s81, 1
    s_cmp_gt_u32 s81, 50000
    s_cbranch_scc1 L_fm10_ok
    s_waitcnt vmcnt(0)
    v_cmp_ne_u32 vcc, v43, v42
    s_nop 1
    s_and_b32 s78, vcc_lo, s18
    s_cbranch_scc1 L_fm10_spin
L_fm10_ok:
    s_mul_i32 s83, s64, 8
    buffer_load_dwordx4 v[152:155], v26, s[28:31], s83 offen sc1
    v_mfma_f32_32x32x16_bf16 v[104:119], a[208:211], a[84:87], v[104:119]
    v_mfma_f32_32x32x16_bf16 v[136:151], a[212:215], a[84:87], v[136:151]
    buffer_load_dwordx4 v[156:159], v27, s[28:31], s83 offen sc1
    s_mul_i32 s83, s65, 8
    buffer_load_dwordx4 v[160:163], v26, s[28:31], s83 offen sc1
    s_waitcnt vmcnt(8)
    v_mfma_f32_32x32x16_bf16 v[88:103], a[216:219], a[88:91], v[88:103]
    v_mfma_f32_32x32x16_bf16 v[120:135], a[220:223], a[88:91], v[120:135]
    buffer_load_dwordx4 v[164:167], v27, s[28:31], s83 offen sc1
    s_waitcnt vmcnt(8)
    v_mfma_f32_32x32x16_bf16 v[104:119], a[216:219], a[92:95], v[104:119]
    v_mfma_f32_32x32x16_bf16 v[136:151], a[220:223], a[92:95], v[136:151]
    s_mul_i32 s83, s66, 8
    buffer_load_dwordx4 v[168:171], v26, s[28:31], s83 offen sc1
    s_waitcnt vmcnt(8)
    v_mfma_f32_32x32x16_bf16 v[88:103], a[224:227], a[96:99], v[88:103]
    v_mfma_f32_32x32x16_bf16 v[120:135], a[228:231], a[96:99], v[120:135]
    buffer_load_dwordx4 v[172:175], v27, s[28:31], s83 offen sc1
    s_waitcnt vmcnt(8)
    v_mfma_f32_32x32x16_bf16 v[104:119], a[224:227], a[100:103], v[104:119]
    v_mfma_f32_32x32x16_bf16 v[136:151], a[228:231], a[100:103], v[136:151]
    s_mul_i32 s83, s67, 8
    buffer_load_dwordx4 v[176:179], v26, s[28:31], s83 offen sc1
    s_waitcnt vmcnt(8)
    v_mfma_f32_32x32x16_bf16 v[88:103], a[232:235], a[104:107], v[88:103]
    v_mfma_f32_32x32x16_bf16 v[120:135], a[236:239], a[104:107], v[120:135]
    buffer_load_dwordx4 v[180:183], v27, s[28:31], s83 offen sc1
    s_waitcnt vmcnt(8)
    v_mfma_f32_32x32x16_bf16 v[104:119], a[232:235], a[108:111], v[104:119]
    v_mfma_f32_32x32x16_bf16 v[136:151], a[236:239], a[108:111], v[136:151]
    buffer_load_dword v43, v44, s[28:31], 0 offen offset:128 sc1
    s_waitcnt vmcnt(8)
    v_mfma_f32_32x32x16_bf16 v[88:103], a[240:243], v[152:155], v[88:103]
    v_mfma_f32_32x32x16_bf16 v[120:135], a[244:247], v[152:155], v[120:135]
    s_mul_i32 s83, s68, 8
    buffer_load_dwordx4 v[184:187], v26, s[28:31], s83 offen sc1
    s_waitcnt vmcnt(8)
    v_mfma_f32_32x32x16_bf16 v[104:119], a[240:243], v[156:159], v[104:119]
    v_mfma_f32_32x32x16_bf16 v[136:151], a[244:247], v[156:159], v[136:151]
    buffer_load_dwordx4 v[188:191], v27, s[28:31], s83 offen sc1
    s_waitcnt vmcnt(8)
    v_mfma_f32_32x32x16_bf16 v[88:103], a[248:251], v[160:163], v[88:103]
    v_mfma_f32_32x32x16_bf16 v[120:135], a[252:255], v[160:163], v[120:135]
    s_mul_i32 s83, s69, 8
    buffer_load_dwordx4 v[192:195], v26, s[28:31], s83 offen sc1
    s_waitcnt vmcnt(8)
    v_mfma_f32_32x32x16_bf16 v[104:119], a[248:251], v[164:167], v[104:119]
    v_mfma_f32_32x32x16_bf16 v[136:151], a[252:255], v[164:167], v[136:151]
    buffer_load_dwordx4 v[196:199], v27, s[28:31], s83 offen sc1
    s_waitcnt vmcnt(8)
    v_mfma_f32_32x32x16_bf16 v[88:103], v[216:219], v[168:171], v[88:103]
    v_mfma_f32_32x32x16_bf16 v[120:135], v[220:223], v[168:171], v[120:135]
    s_mul_i32 s83, s70, 8
    buffer_load_dwordx4 v[200:203], v26, s[28:31], s83 offen sc1
    s_waitcnt vmcnt(8)
    v_mfma_f32_32x32x16_bf16 v[104:119], v[216:219], v[172:175], v[104:119]
    v_mfma_f32_32x32x16_bf16 v[136:151], v[220:223], v[172:175], v[136:151]
    buffer_load_dwordx4 v[204:207], v27, s[28:31], s83 offen sc1
    s_waitcnt vmcnt(8)
    v_mfma_f32_32x32x16_bf16 v[88:103], v[224:227], v[176:179], v[88:103]
    v_mfma_f32_32x32x16_bf16 v[120:135], v[228:231], v[176:179], v[120:135]
    s_waitcnt vmcnt(6)
    v_cmp_ne_u32 vcc, v43, v42
    s_nop 1
    s_and_b32 s78, vcc_lo, s19
    s_cbranch_scc0 L_fm11_ok
    s_mov_b32 s81, 0
L_fm11_spin:
    buffer_load_dword v43, v44, s[28:31], 0 offen offset:128 sc1
    s_add_u32 s81, s81, 1
    s_cmp_gt_u32 s81, 50000
    s_cbranch_scc1 L_fm11_ok
    s_waitcnt vmcnt(0)
    v_cmp_ne_u32 vcc, v43, v42
    s_nop 1
    s_and_b32 s78, vcc_lo, s19
    s_cbranch_scc1 L_fm11_spin
L_fm11_ok:
    s_mul_i32 s83, s71, 8
    buffer_load_dwordx4 v[208:211], v26, s[28:31], s83 offen sc1
    v_mfma_f32_32x32x16_bf16 v[104:119], v[224:227], v[180:183], v[104:119]
    v_mfma_f32_32x32x16_bf16 v[136:151], v[228:231], v[180:183], v[136:151]
    buffer_load_dwordx4 v[212:215], v27, s[28:31], s83 offen sc1
    s_mul_i32 s83, s72, 8
    buffer_load_dwordx4 v[56:59], v26, s[28:31], s83 offen sc1
    s_waitcnt vmcnt(8)
    v_mfma_f32_32x32x16_bf16 v[88:103], v[232:235], v[184:187], v[88:103]
    v_mfma_f32_32x32x16_bf16 v[120:135], v[236:239], v[184:187], v[120:135]
    buffer_load_dwordx4 v[60:63], v27, s[28:31], s83 offen sc1
    s_waitcnt vmcnt(8)
    v_mfma_f32_32x32x16_bf16 v[104:119], v[232:235], v[188:191], v[104:119]
    v_mfma_f32_32x32x16_bf16 v[136:151], v[236:239], v[188:191], v[136:151]
    s_mul_i32 s83, s73, 8
    buffer_load_dwordx4 v[64:67], v26, s[28:31], s83 offen sc1
    s_waitcnt vmcnt(8)
    v_mfma_f32_32x32x16_bf16 v[88:103], v[240:243], v[192:195], v[88:103]
    v_mfma_f32_32x32x16_bf16 v[120:135], v[244:247], v[192:195], v[120:135]
    buffer_load_dwordx4 v[68:71], v27, s[28:31], s83 offen sc1
    s_waitcnt vmcnt(8)
    v_mfma_f32_32x32x16_bf16 v[104:119], v[240:243], v[196:199], v[104:119]
    v_mfma_f32_32x32x16_bf16 v[136:151], v[244:247], v[196:199], v[136:151]
    s_mul_i32 s83, s74, 8
    buffer_load_dwordx4 v[72:75], v26, s[28:31], s83 offen sc1
    s_waitcnt vmcnt(8)
    s_waitcnt lgkmcnt(15)
    v_mfma_f32_32x32x16_bf16 v[88:103], v[248:251], v[200:203], v[88:103]
    v_mfma_f32_32x32x16_bf16 v[120:135], v[252:255], v[200:203], v[120:135]
    buffer_load_dwordx4 v[76:79], v27, s[28:31], s83 offen sc1
    s_waitcnt vmcnt(8)
    v_mfma_f32_32x32x16_bf16 v[104:119], v[248:251], v[204:207], v[104:119]
    v_mfma_f32_32x32x16_bf16 v[136:151], v[252:255], v[204:207], v[136:151]
    s_mul_i32 s83, s75, 8
    buffer_load_dwordx4 v[80:83], v26, s[28:31], s83 offen sc1
    s_waitcnt vmcnt(8)
    v_mfma_f32_32x32x16_bf16 v[88:103], a[128:131], v[208:211], v[88:103]
    v_mfma_f32_32x32x16_bf16 v[120:135], a[132:135], v[208:211], v[120:135]
    buffer_load_dwordx4 v[84:87], v27, s[28:31], s83 offen sc1
    s_waitcnt vmcnt(8)
    v_mfma_f32_32x32x16_bf16 v[104:119], a[128:131], v[212:215], v[104:119]
    v_mfma_f32_32x32x16_bf16 v[136:151], a[132:135], v[212:215], v[136:151]
    s_mul_i32 s83, s76, 8
    buffer_load_dwordx4 a[112:115], v26, s[28:31], s83 offen sc1
    s_waitcnt vmcnt(8)
    v_mfma_f32_32x32x16_bf16 v[88:103], a[136:139], v[56:59], v[88:103]
    v_mfma_f32_32x32x16_bf16 v[120:135], a[140:143], v[56:59], v[120:135]
    buffer_load_dwordx4 a[116:119], v27, s[28:31], s83 offen sc1
    s_waitcnt vmcnt(8)
    v_mfma_f32_32x32x16_bf16 v[104:119], a[136:139], v[60:63], v[104:119]
    v_mfma_f32_32x32x16_bf16 v[136:151], a[140:143], v[60:63], v[136:151]
    s_mul_i32 s83, s77, 8
    buffer_load_dwordx4 a[120:123], v26, s[28:31], s83 offen sc1
    s_waitcnt vmcnt(8)
    v_mfma_f32_32x32x16_bf16 v[88:103], a[144:147], v[64:67], v[88:103]
    v_mfma_f32_32x32x16_bf16 v[120:135], a[148:151], v[64:67], v[120:135]
    buffer_load_dwordx4 a[124:127], v27, s[28:31], s83 offen sc1
    s_waitcnt vmcnt(8)
    v_mfma_f32_32x32x16_bf16 v[104:119], a[144:147], v[68:71], v[104:119]
    v_mfma_f32_32x32x16_bf16 v[136:151], a[148:151], v[68:71], v[136:151]
    s_waitcnt vmcnt(7)
    s_waitcnt lgkmcnt(12)
    v_mfma_f32_32x32x16_bf16 v[88:103], a[152:155], v[72:75], v[88:103]
    v_mfma_f32_32x32x16_bf16 v[120:135], a[156:159], v[72:75], v[120:135]
    s_waitcnt vmcnt(6)
    v_mfma_f32_32x32x16_bf16 v[104:119], a[152:155], v[76:79], v[104:119]
    v_mfma_f32_32x32x16_bf16 v[136:151], a[156:159], v[76:79], v[136:151]
    s_waitcnt vmcnt(5)
    s_waitcnt lgkmcnt(8)
    v_mfma_f32_32x32x16_bf16 v[88:103], a[160:163], v[80:83], v[88:103]
    v_mfma_f32_32x32x16_bf16 v[120:135], a[164:167], v[80:83], v[120:135]
    s_waitcnt vmcnt(4)
    v_mfma_f32_32x32x16_bf16 v[104:119], a[160:163], v[84:87], v[104:119]
    v_mfma_f32_32x32x16_bf16 v[136:151], a[164:167], v[84:87], v[136:151]
    s_waitcnt vmcnt(3)
    s_waitcnt lgkmcnt(4)
    v_mfma_f32_32x32x16_bf16 v[88:103], a[168:171], a[112:115], v[88:103]
    v_mfma_f32_32x32x16_bf16 v[120:135], a[172:175], a[112:115], v[120:135]
    s_waitcnt vmcnt(2)
    v_mfma_f32_32x32x16_bf16 v[104:119], a[168:171], a[116:119], v[104:119]
    v_mfma_f32_32x32x16_bf16 v[136:151], a[172:175], a[116:119], v[136:151]
    s_waitcnt vmcnt(1)
    s_waitcnt lgkmcnt(0)
    v_mfma_f32_32x32x16_bf16 v[88:103], a[176:179], a[120:123], v[88:103]
    v_mfma_f32_32x32x16_bf16 v[120:135], a[180:183], a[120:123], v[120:135]
    s_waitcnt vmcnt(0)
    v_mfma_f32_32x32x16_bf16 v[104:119], a[176:179], a[124:127], v[104:119]
    v_mfma_f32_32x32x16_bf16 v[136:151], a[180:183], a[124:127], v[136:151]
    s_branch L_red
L_spare:
    s_waitcnt lgkmcnt(0)
    s_mov_b32 s28, s16
    s_mov_b32 s29, s17
    s_mov_b32 s30, 18874368
    s_mov_b32 s31, 0x00020000
    buffer_load_dword v42, v45, s[28:31], s15 offen sc1
    s_cmp_lt_u32 s3, 2
    s_cselect_b32 s24, s6, s8
    s_cselect_b32 s25, s7, s9
    s_mov_b32 s26, 1835008
    s_mov_b32 s27, 0x00020000
    s_and_b32 s78, s40, 3
    s_lshl_b32 s78, s78, 1
    s_and_b32 s79, s3, 1
    s_add_u32 s78, s78, s79
    s_mul_i32 s78, s78, 229376
    s_mul_i32 s79, s43, 1792
    s_add_u32 s78, s78, s79
    v_mul_u32_u24 v12, 3584, v2
    v_add_u32 v12, s78, v12
    s_lshr_b32 s78, s40, 2
    s_lshl_b32 s78, s78, 9
    s_mov_b32 s56, s78
    s_add_u32 s78, s78, 256
    s_cmp_eq_u32 s78, 1792
    s_cselect_b32 s78, 0, s78
    s_mov_b32 s57, s78
    s_add_u32 s78, s78, 256
    s_cmp_eq_u32 s78, 1792
    s_cselect_b32 s78, 0, s78
    s_mov_b32 s58, s78
    s_add_u32 s78, s78, 256
    s_cmp_eq_u32 s78, 1792
    s_cselect_b32 s78, 0, s78
    s_mov_b32 s59, s78
    s_add_u32 s78, s78, 256
    s_cmp_eq_u32 s78, 1792
    s_cselect_b32 s78, 0, s78
    s_mov_b32 s60, s78
    s_add_u32 s78, s78, 256
    s_cmp_eq_u32 s78, 1792
    s_cselect_b32 s78, 0, s78
    s_mov_b32 s61, s78
    s_add_u32 s78, s78, 256
    s_cmp_eq_u32 s78, 1792
    s_cselect_b32 s78, 0, s78
    s_mov_b32 s62, s78
    s_add_u32 s78, s78, 256
    s_cmp_eq_u32 s78, 1792
    s_cselect_b32 s78, 0, s78
    buffer_load_dword v47, v12, s[24:27], s56 offen offset:128
    buffer_load_dword v47, v12, s[24:27], s57 offen offset:128
    v_lshrrev_b32 v1, 5, v2
    v_bfe_u32 v4, v2, 2, 2
    v_bfe_u32 v3, v2, 4, 1
    v_and_b32 v7, 3, v2
    v_lshlrev_b32 v7, 3, v7
    v_lshlrev_b32 v6, 2, v1
    v_add_u32 v6, v6, v4
    v_lshlrev_b32 v6, 7, v6
    v_bfe_u32 v4, v2, 3, 1
    v_lshlrev_b32 v4, 6, v4
    v_lshlrev_b32 v3, 5, v3
    v_add3_u32 v6, v6, v4, v3
    v_add3_u32 v40, v6, v7, s44
    v_xor_b32 v41, 64, v40
    s_add_u32 s81, s41, 6
    s_and_b32 s81, s81, 7
    s_lshl_b32 s79, s81, 7
    s_lshl_b32 s80, s3, 14
    s_add_u32 s79, s79, s80
    v_lshrrev_b32 v3, 3, v2
    v_and_b32 v4, 7, v2
    v_bfe_u32 v6, v2, 4, 1
    v_lshlrev_b32 v6, 2, v6
    v_xor_b32 v4, v4, v6
    v_lshlrev_b32 v4, 4, v4
    v_lshlrev_b32 v3, 10, v3
    v_add3_u32 v20, v3, v4, s79
    v_add_u32 v21, 7168, v20
    v_add_u32 v22, 65536, v20
    v_add_u32 v23, 65536, v21
    s_cmp_ge_u32 s82, 7
    s_cselect_b32 s79, 7, 0
    s_sub_u32 s78, s82, s79
    s_lshl_b32 s78, s78, 10
    s_mul_i32 s79, s43, 7168
    s_sub_u32 s80, 7168, s79
    s_add_u32 s64, s78, s79
    s_add_u32 s71, s78, s80
    s_add_u32 s78, s78, 1024
    s_cmp_eq_u32 s78, 7168
    s_cselect_b32 s78, 0, s78
    s_add_u32 s65, s78, s79
    s_add_u32 s72, s78, s80
    s_add_u32 s78, s78, 1024
    s_cmp_eq_u32 s78, 7168
    s_cselect_b32 s78, 0, s78
    s_add_u32 s66, s78, s79
    s_add_u32 s73, s78, s80
    s_add_u32 s78, s78, 1024
    s_cmp_eq_u32 s78, 7168
    s_cselect_b32 s78, 0, s78
    s_add_u32 s67, s78, s79
    s_add_u32 s74, s78, s80
    s_add_u32 s78, s78, 1024
    s_cmp_eq_u32 s78, 7168
    s_cselect_b32 s78, 0, s78
    s_add_u32 s68, s78, s79
    s_add_u32 s75, s78, s80
    s_add_u32 s78, s78, 1024
    s_cmp_eq_u32 s78, 7168
    s_cselect_b32 s78, 0, s78
    s_add_u32 s69, s78, s79
    s_add_u32 s76, s78, s80
    s_add_u32 s78, s78, 1024
    s_cmp_eq_u32 s78, 7168
    s_cselect_b32 s78, 0, s78
    s_add_u32 s70, s78, s79
    s_add_u32 s77, s78, s80
    s_lshl_b32 s78, s40, 1
    s_add_u32 s78, s78, s43
    s_mul_i32 s79, s43, 229376
    s_lshl_b32 s80, s3, 10
    s_add_u32 s79, s79, s80
    s_mul_i32 s80, s40, 1048576
    s_add_u32 s79, s79, s80
    v_lshlrev_b32 v46, 4, v2
    v_add_u32 v24, s79, v46
    v_add_u32 v25, 114688, v24
    v_add_u32 v26, 4096, v24
    v_add_u32 v27, 4096, v25
    s_lshl_b32 s79, s43, 8
    s_add_u32 s79, s79, s15
    s_sub_u32 s79, s79, 1024
    v_min_u32 v3, 29, v2
    v_lshlrev_b32 v3, 2, v3
    v_add_u32 v44, s79, v3
    s_cmp_eq_u32 s43, 0
    s_mov_b32 s79, 0x10003fff
    s_mov_b32 s80, 0x2fffc000
    s_cselect_b32 s18, s79, s80
    s_cselect_b32 s19, s80, s79
    s_mov_b32 s32, s10
    s_mov_b32 s33, s11
    s_mov_b32 s34, 1835008
    s_mov_b32 s35, 0x00020000
    s_mov_b32 s36, s12
    s_mov_b32 s37, s13
    s_mov_b32 s38, 2097152
    s_mov_b32 s39, 0x00020000
    s_lshl_b32 s14, s78, 16
    s_lshl_b32 s79, s81, 7
    s_add_u32 s14, s14, s79
    s_and_b32 s78, s2, 31
    s_lshl_b32 s78, s78, 2
    s_add_u32 s78, s78, s3
    s_mul_i32 s78, s78, 14336
    v_lshlrev_b32 v13, 7, v2
    v_add_u32 v13, s78, v13
    v_min_u32 v14, 47, v2
    v_lshlrev_b32 v14, 7, v14
    v_add_u32 v14, 8192, v14
    v_add_u32 v14, s78, v14
    s_waitcnt vmcnt(2)
    v_add_u32 v42, 1, v42
    s_barrier
    s_lshl_b32 s79, s3, 7
    s_lshl_b32 s80, s43, 2
    s_add_u32 s79, s79, s80
    s_add_u32 s79, s79, s15
    s_sub_u32 s79, s79, 912
    s_mov_b64 exec, 1
    buffer_store_dword v42, v45, s[28:31], s79 offen sc1
    s_mov_b64 exec, -1
    s_and_b32 s78, s40, 3
    s_lshl2_add_u32 s78, s78, s3
    s_and_b32 s79, s78, 7
    s_lshl_b32 s79, s79, 13
    v_lshlrev_b32 v15, 7, v2
    v_add_u32 v15, s79, v15
    v_add_u32 v16, 65536, v15
    s_lshr_b32 s78, s78, 3
    s_mul_i32 s79, s43, 7
    s_add_u32 s55, s78, s79
    s_add_u32 s78, s55, 0
    s_sub_u32 s79, s78, 14
    s_cselect_b32 s78, s78, s79
    s_lshl_b32 s48, s78, 17
    s_add_u32 s78, s55, 2
    s_sub_u32 s79, s78, 14
    s_cselect_b32 s78, s78, s79
    s_lshl_b32 s49, s78, 17
    s_add_u32 s78, s55, 4
    s_sub_u32 s79, s78, 14
    s_cselect_b32 s78, s78, s79
    s_lshl_b32 s50, s78, 17
    s_add_u32 s78, s55, 6
    s_sub_u32 s79, s78, 14
    s_cselect_b32 s78, s78, s79
    s_lshl_b32 s51, s78, 17
    s_add_u32 s78, s55, 8
    s_sub_u32 s79, s78, 14
    s_cselect_b32 s78, s78, s79
    s_lshl_b32 s52, s78, 17
    s_add_u32 s78, s55, 10
    s_sub_u32 s79, s78, 14
    s_cselect_b32 s78, s78, s79
    s_lshl_b32 s53, s78, 17
    s_add_u32 s78, s55, 12
    s_sub_u32 s79, s78, 14
    s_cselect_b32 s78, s78, s79
    s_lshl_b32 s54, s78, 17
    buffer_load_dword v47, v13, s[32:35], 0 offen
    buffer_load_dword v47, v14, s[32:35], 0 offen
    buffer_load_dword v47, v12, s[24:27], s58 offen offset:128
    buffer_load_dword v47, v12, s[24:27], s59 offen offset:128
    buffer_load_dword v47, v12, s[24:27], s60 offen offset:128
    buffer_load_dword v47, v12, s[24:27], s61 offen offset:128
    buffer_load_dword v47, v12, s[24:27], s62 offen offset:128
    buffer_load_dword v47, v15, s[32:35], s48 offen
    buffer_load_dword v47, v15, s[32:35], s49 offen
    buffer_load_dword v47, v15, s[32:35], s50 offen
    buffer_load_dword v47, v15, s[32:35], s51 offen
    buffer_load_dword v47, v15, s[32:35], s52 offen
    buffer_load_dword v47, v15, s[32:35], s53 offen
    buffer_load_dword v47, v15, s[32:35], s54 offen
    s_add_u32 m0, s44, 0
    s_lshl_b32 s82, s64, 7
    buffer_load_dwordx4 v20, s[32:35], s82 offen lds
    buffer_load_dwordx4 v21, s[32:35], s82 offen offset:1024 lds
    s_add_u32 m0, s44, 2048
    s_lshl_b32 s82, s65, 7
    buffer_load_dwordx4 v20, s[32:35], s82 offen lds
    buffer_load_dwordx4 v21, s[32:35], s82 offen offset:1024 lds
    s_add_u32 m0, s44, 4096
    s_lshl_b32 s82, s66, 7
    buffer_load_dwordx4 v20, s[32:35], s82 offen lds
    buffer_load_dwordx4 v21, s[32:35], s82 offen offset:1024 lds
    s_add_u32 m0, s44, 6144
    s_lshl_b32 s82, s67, 7
    buffer_load_dwordx4 v20, s[32:35], s82 offen lds
    buffer_load_dwordx4 v21, s[32:35], s82 offen offset:1024 lds
    s_add_u32 m0, s44, 8192
    s_lshl_b32 s82, s68, 7
    buffer_load_dwordx4 v20, s[32:35], s82 offen lds
    buffer_load_dwordx4 v21, s[32:35], s82 offen offset:1024 lds
    s_add_u32 m0, s44, 10240
    s_lshl_b32 s82, s69, 7
    buffer_load_dwordx4 v20, s[32:35], s82 offen lds
    buffer_load_dwordx4 v21, s[32:35], s82 offen offset:1024 lds
    s_waitcnt vmcnt(10)
    ds_read_b64_tr_b16 a[128:129], v40 offset:0
    ds_read_b64_tr_b16 a[130:131], v40 offset:1024
    ds_read_b64_tr_b16 a[132:133], v41 offset:0
    ds_read_b64_tr_b16 a[134:135], v41 offset:1024
    s_add_u32 m0, s44, 12288
    s_lshl_b32 s82, s70, 7
    buffer_load_dwordx4 v20, s[32:35], s82 offen lds
    buffer_load_dwordx4 v21, s[32:35], s82 offen offset:1024 lds
    s_waitcnt vmcnt(10)
    ds_read_b64_tr_b16 a[136:137], v40 offset:2048
    ds_read_b64_tr_b16 a[138:139], v40 offset:3072
    ds_read_b64_tr_b16 a[140:141], v41 offset:2048
    ds_read_b64_tr_b16 a[142:143], v41 offset:3072
    s_add_u32 m0, s44, 14336
    s_lshl_b32 s82, s71, 7
    buffer_load_dwordx4 v20, s[32:35], s82 offen lds
    buffer_load_dwordx4 v21, s[32:35], s82 offen offset:1024 lds
    s_waitcnt vmcnt(10)
    ds_read_b64_tr_b16 a[144:145], v40 offset:4096
    ds_read_b64_tr_b16 a[146:147], v40 offset:5120
    ds_read_b64_tr_b16 a[148:149], v41 offset:4096
    ds_read_b64_tr_b16 a[150:151], v41 offset:5120
    s_add_u32 m0, s44, 0
    s_waitcnt lgkmcnt(8)
    s_lshl_b32 s82, s72, 7
    buffer_load_dwordx4 v20, s[32:35], s82 offen lds
    buffer_load_dwordx4 v21, s[32:35], s82 offen offset:1024 lds
    s_waitcnt vmcnt(10)
    ds_read_b64_tr_b16 a[152:153], v40 offset:6144
    ds_read_b64_tr_b16 a[154:155], v40 offset:7168
    ds_read_b64_tr_b16 a[156:157], v41 offset:6144
    ds_read_b64_tr_b16 a[158:159], v41 offset:7168
    s_add_u32 m0, s44, 2048
    s_waitcnt lgkmcnt(8)
    s_lshl_b32 s82, s73, 7
    buffer_load_dwordx4 v20, s[32:35], s82 offen lds
    buffer_load_dwordx4 v21, s[32:35], s82 offen offset:1024 lds
    s_waitcnt vmcnt(10)
    ds_read_b64_tr_b16 a[160:161], v40 offset:8192
    ds_read_b64_tr_b16 a[162:163], v40 offset:9216
    ds_read_b64_tr_b16 a[164:165], v41 offset:8192
    ds_read_b64_tr_b16 a[166:167], v41 offset:9216
    s_add_u32 m0, s44, 4096
    s_waitcnt lgkmcnt(8)
    s_lshl_b32 s82, s74, 7
    buffer_load_dwordx4 v20, s[32:35], s82 offen lds
    buffer_load_dwordx4 v21, s[32:35], s82 offen offset:1024 lds
    s_waitcnt vmcnt(10)
    ds_read_b64_tr_b16 a[168:169], v40 offset:10240
    ds_read_b64_tr_b16 a[170:171], v40 offset:11264
    ds_read_b64_tr_b16 a[172:173], v41 offset:10240
    ds_read_b64_tr_b16 a[174:175], v41 offset:11264
    s_add_u32 m0, s44, 6144
    s_waitcnt lgkmcnt(8)
    s_lshl_b32 s82, s75, 7
    buffer_load_dwordx4 v20, s[32:35], s82 offen lds
    buffer_load_dwordx4 v21, s[32:35], s82 offen offset:1024 lds
    s_waitcnt vmcnt(10)
    ds_read_b64_tr_b16 a[176:177], v40 offset:12288
    ds_read_b64_tr_b16 a[178:179], v40 offset:13312
    ds_read_b64_tr_b16 a[180:181], v41 offset:12288
    ds_read_b64_tr_b16 a[182:183], v41 offset:13312
    s_add_u32 m0, s44, 8192
    s_waitcnt lgkmcnt(8)
    s_lshl_b32 s82, s76, 7
    buffer_load_dwordx4 v20, s[32:35], s82 offen lds
    buffer_load_dwordx4 v21, s[32:35], s82 offen offset:1024 lds
    s_waitcnt vmcnt(10)
    ds_read_b64_tr_b16 a[184:185], v40 offset:14336
    ds_read_b64_tr_b16 a[186:187], v40 offset:15360
    ds_read_b64_tr_b16 a[188:189], v41 offset:14336
    ds_read_b64_tr_b16 a[190:191], v41 offset:15360
    s_add_u32 m0, s44, 10240
    s_waitcnt lgkmcnt(8)
    s_lshl_b32 s82, s77, 7
    buffer_load_dwordx4 v20, s[32:35], s82 offen lds
    buffer_load_dwordx4 v21, s[32:35], s82 offen offset:1024 lds
    s_waitcnt vmcnt(10)
    ds_read_b64_tr_b16 a[192:193], v40 offset:0
    ds_read_b64_tr_b16 a[194:195], v40 offset:1024
    ds_read_b64_tr_b16 a[196:197], v41 offset:0
    ds_read_b64_tr_b16 a[198:199], v41 offset:1024
    s_add_u32 m0, s44, 12288
    s_waitcnt lgkmcnt(8)
    s_lshl_b32 s82, s64, 7
    buffer_load_dwordx4 v22, s[32:35], s82 offen lds
    buffer_load_dwordx4 v23, s[32:35], s82 offen offset:1024 lds
    s_waitcnt vmcnt(10)
    ds_read_b64_tr_b16 a[200:201], v40 offset:2048
    ds_read_b64_tr_b16 a[202:203], v40 offset:3072
    ds_read_b64_tr_b16 a[204:205], v41 offset:2048
    ds_read_b64_tr_b16 a[206:207], v41 offset:3072
    s_add_u32 m0, s44, 14336
    s_waitcnt lgkmcnt(8)
    s_lshl_b32 s82, s65, 7
    buffer_load_dwordx4 v22, s[32:35], s82 offen lds
    buffer_load_dwordx4 v23, s[32:35], s82 offen offset:1024 lds
    s_waitcnt vmcnt(10)
    ds_read_b64_tr_b16 a[208:209], v40 offset:4096
    ds_read_b64_tr_b16 a[210:211], v40 offset:5120
    ds_read_b64_tr_b16 a[212:213], v41 offset:4096
    ds_read_b64_tr_b16 a[214:215], v41 offset:5120
    s_add_u32 m0, s44, 0
    s_waitcnt lgkmcnt(8)
    s_lshl_b32 s82, s66, 7
    buffer_load_dwordx4 v22, s[32:35], s82 offen lds
    buffer_load_dwordx4 v23, s[32:35], s82 offen offset:1024 lds
    s_waitcnt vmcnt(10)
    ds_read_b64_tr_b16 a[216:217], v40 offset:6144
    ds_read_b64_tr_b16 a[218:219], v40 offset:7168
    ds_read_b64_tr_b16 a[220:221], v41 offset:6144
    ds_read_b64_tr_b16 a[222:223], v41 offset:7168
    s_add_u32 m0, s44, 2048
    s_waitcnt lgkmcnt(8)
    s_lshl_b32 s82, s67, 7
    buffer_load_dwordx4 v22, s[32:35], s82 offen lds
    buffer_load_dwordx4 v23, s[32:35], s82 offen offset:1024 lds
    s_waitcnt vmcnt(10)
    ds_read_b64_tr_b16 a[224:225], v40 offset:8192
    ds_read_b64_tr_b16 a[226:227], v40 offset:9216
    ds_read_b64_tr_b16 a[228:229], v41 offset:8192
    ds_read_b64_tr_b16 a[230:231], v41 offset:9216
    s_add_u32 m0, s44, 4096
    s_waitcnt lgkmcnt(8)
    s_lshl_b32 s82, s68, 7
    buffer_load_dwordx4 v22, s[32:35], s82 offen lds
    buffer_load_dwordx4 v23, s[32:35], s82 offen offset:1024 lds
    s_waitcnt vmcnt(10)
    ds_read_b64_tr_b16 a[232:233], v40 offset:10240
    ds_read_b64_tr_b16 a[234:235], v40 offset:11264
    ds_read_b64_tr_b16 a[236:237], v41 offset:10240
    ds_read_b64_tr_b16 a[238:239], v41 offset:11264
    s_add_u32 m0, s44, 6144
    s_waitcnt lgkmcnt(8)
    s_lshl_b32 s82, s69, 7
    buffer_load_dwordx4 v22, s[32:35], s82 offen lds
    buffer_load_dwordx4 v23, s[32:35], s82 offen offset:1024 lds
    s_waitcnt vmcnt(10)
    ds_read_b64_tr_b16 a[240:241], v40 offset:12288
    ds_read_b64_tr_b16 a[242:243], v40 offset:13312
    ds_read_b64_tr_b16 a[244:245], v41 offset:12288
    ds_read_b64_tr_b16 a[246:247], v41 offset:13312
    s_add_u32 m0, s44, 8192
    s_waitcnt lgkmcnt(8)
    s_lshl_b32 s82, s70, 7
    buffer_load_dwordx4 v22, s[32:35], s82 offen lds
    buffer_load_dwordx4 v23, s[32:35], s82 offen offset:1024 lds
    s_waitcnt vmcnt(10)
    ds_read_b64_tr_b16 a[248:249], v40 offset:14336
    ds_read_b64_tr_b16 a[250:251], v40 offset:15360
    ds_read_b64_tr_b16 a[252:253], v41 offset:14336
    ds_read_b64_tr_b16 a[254:255], v41 offset:15360
    s_add_u32 m0, s44, 10240
    s_waitcnt lgkmcnt(8)
    s_lshl_b32 s82, s71, 7
    buffer_load_dwordx4 v22, s[32:35], s82 offen lds
    buffer_load_dwordx4 v23, s[32:35], s82 offen offset:1024 lds
    s_waitcnt vmcnt(10)
    ds_read_b64_tr_b16 v[216:217], v40 offset:0
    ds_read_b64_tr_b16 v[218:219], v40 offset:1024
    ds_read_b64_tr_b16 v[220:221], v41 offset:0
    ds_read_b64_tr_b16 v[222:223], v41 offset:1024
    s_add_u32 m0, s44, 12288
    s_waitcnt lgkmcnt(8)
    s_lshl_b32 s82, s72, 7
    buffer_load_dwordx4 v22, s[32:35], s82 offen lds
    buffer_load_dwordx4 v23, s[32:35], s82 offen offset:1024 lds
    s_waitcnt vmcnt(10)
    ds_read_b64_tr_b16 v[224:225], v40 offset:2048
    ds_read_b64_tr_b16 v[226:227], v40 offset:3072
    ds_read_b64_tr_b16 v[228:229], v41 offset:2048
    ds_read_b64_tr_b16 v[230:231], v41 offset:3072
    s_add_u32 m0, s44, 14336
    s_waitcnt lgkmcnt(8)
    s_lshl_b32 s82, s73, 7
    buffer_load_dwordx4 v22, s[32:35], s82 offen lds
    buffer_load_dwordx4 v23, s[32:35], s82 offen offset:1024 lds
    s_waitcnt vmcnt(10)
    ds_read_b64_tr_b16 v[232:233], v40 offset:4096
    ds_read_b64_tr_b16 v[234:235], v40 offset:5120
    ds_read_b64_tr_b16 v[236:237], v41 offset:4096
    ds_read_b64_tr_b16 v[238:239], v41 offset:5120
    s_add_u32 m0, s44, 0
    s_waitcnt lgkmcnt(8)
    s_lshl_b32 s82, s74, 7
    buffer_load_dwordx4 v22, s[32:35], s82 offen lds
    buffer_load_dwordx4 v23, s[32:35], s82 offen offset:1024 lds
    s_waitcnt vmcnt(10)
    ds_read_b64_tr_b16 v[240:241], v40 offset:6144
    ds_read_b64_tr_b16 v[242:243], v40 offset:7168
    ds_read_b64_tr_b16 v[244:245], v41 offset:6144
    ds_read_b64_tr_b16 v[246:247], v41 offset:7168
    buffer_load_dword v43, v44, s[28:31], 0 offen sc1
    s_add_u32 m0, s44, 2048
    s_waitcnt lgkmcnt(8)
    s_lshl_b32 s82, s75, 7
    buffer_load_dwordx4 v22, s[32:35], s82 offen lds
    s_waitcnt vmcnt(10)
    ds_read_b64_tr_b16 v[248:249], v40 offset:8192
    ds_read_b64_tr_b16 v[250:251], v40 offset:9216
    ds_read_b64_tr_b16 v[252:253], v41 offset:8192
    ds_read_b64_tr_b16 v[254:255], v41 offset:9216
    buffer_load_dwordx4 v23, s[32:35], s82 offen offset:1024 lds
    s_add_u32 m0, s44, 4096
    s_waitcnt lgkmcnt(8)
    s_lshl_b32 s82, s76, 7
    buffer_load_dwordx4 v22, s[32:35], s82 offen lds
    buffer_load_dwordx4 v23, s[32:35], s82 offen offset:1024 lds
    s_add_u32 m0, s44, 6144
    s_waitcnt lgkmcnt(4)
    s_lshl_b32 s82, s77, 7
    buffer_load_dwordx4 v22, s[32:35], s82 offen lds
    buffer_load_dwordx4 v23, s[32:35], s82 offen offset:1024 lds
    s_waitcnt vmcnt(6)
    v_cmp_ne_u32 vcc, v43, v42
    s_nop 1
    s_and_b32 s78, vcc_lo, s18
    s_cbranch_scc0 L_fs00_ok
    s_mov_b32 s81, 0
L_fs00_spin:
    buffer_load_dword v43, v44, s[28:31], 0 offen sc1
    s_add_u32 s81, s81, 1
    s_cmp_gt_u32 s81, 50000
    s_cbranch_scc1 L_fs00_ok
    s_waitcnt vmcnt(0)
    v_cmp_ne_u32 vcc, v43, v42
    s_nop 1
    s_and_b32 s78, vcc_lo, s18
    s_cbranch_scc1 L_fs00_spin
L_fs00_ok:
    s_mul_i32 s83, s64, 8
    buffer_load_dwordx4 a[0:3], v24, s[28:31], s83 offen sc1
    buffer_load_dwordx4 a[4:7], v25, s[28:31], s83 offen sc1
    s_mul_i32 s83, s65, 8
    buffer_load_dwordx4 a[8:11], v24, s[28:31], s83 offen sc1
    buffer_load_dwordx4 a[12:15], v25, s[28:31], s83 offen sc1
    s_mul_i32 s83, s66, 8
    buffer_load_dwordx4 a[16:19], v24, s[28:31], s83 offen sc1
    buffer_load_dwordx4 a[20:23], v25, s[28:31], s83 offen sc1
    s_mul_i32 s83, s67, 8
    buffer_load_dwordx4 a[24:27], v24, s[28:31], s83 offen sc1
    buffer_load_dwordx4 a[28:31], v25, s[28:31], s83 offen sc1
    buffer_load_dword v43, v44, s[28:31], 0 offen sc1
    s_waitcnt vmcnt(8)
    v_mfma_f32_32x32x16_bf16 v[88:103], a[128:131], a[0:3], 0
    v_mfma_f32_32x32x16_bf16 v[120:135], a[132:135], a[0:3], 0
    s_mul_i32 s83, s68, 8
    buffer_load_dwordx4 a[32:35], v24, s[28:31], s83 offen sc1
    s_waitcnt vmcnt(8)
    v_mfma_f32_32x32x16_bf16 v[104:119], a[128:131], a[4:7], 0
    v_mfma_f32_32x32x16_bf16 v[136:151], a[132:135], a[4:7], 0
    buffer_load_dwordx4 a[36:39], v25, s[28:31], s83 offen sc1
    ds_read_b64_tr_b16 a[128:129], v40 offset:10240
    ds_read_b64_tr_b16 a[130:131], v40 offset:11264
    ds_read_b64_tr_b16 a[132:133], v41 offset:10240
    ds_read_b64_tr_b16 a[134:135], v41 offset:11264
    s_waitcnt vmcnt(8)
    v_mfma_f32_32x32x16_bf16 v[88:103], a[136:139], a[8:11], v[88:103]
    v_mfma_f32_32x32x16_bf16 v[120:135], a[140:143], a[8:11], v[120:135]
    s_mul_i32 s83, s69, 8
    buffer_load_dwordx4 a[40:43], v24, s[28:31], s83 offen sc1
    s_waitcnt vmcnt(8)
    v_mfma_f32_32x32x16_bf16 v[104:119], a[136:139], a[12:15], v[104:119]
    v_mfma_f32_32x32x16_bf16 v[136:151], a[140:143], a[12:15], v[136:151]
    buffer_load_dwordx4 a[44:47], v25, s[28:31], s83 offen sc1
    ds_read_b64_tr_b16 a[136:137], v40 offset:12288
    ds_read_b64_tr_b16 a[138:139], v40 offset:13312
    ds_read_b64_tr_b16 a[140:141], v41 offset:12288
    ds_read_b64_tr_b16 a[142:143], v41 offset:13312
    s_waitcnt vmcnt(8)
    v_mfma_f32_32x32x16_bf16 v[88:103], a[144:147], a[16:19], v[88:103]
    v_mfma_f32_32x32x16_bf16 v[120:135], a[148:151], a[16:19], v[120:135]
    s_mul_i32 s83, s70, 8
    buffer_load_dwordx4 a[48:51], v24, s[28:31], s83 offen sc1
    s_waitcnt vmcnt(8)
    v_mfma_f32_32x32x16_bf16 v[104:119], a[144:147], a[20:23], v[104:119]
    v_mfma_f32_32x32x16_bf16 v[136:151], a[148:151], a[20:23], v[136:151]
    buffer_load_dwordx4 a[52:55], v25, s[28:31], s83 offen sc1
    ds_read_b64_tr_b16 a[144:145], v40 offset:14336
    ds_read_b64_tr_b16 a[146:147], v40 offset:15360
    ds_read_b64_tr_b16 a[148:149], v41 offset:14336
    ds_read_b64_tr_b16 a[150:151], v41 offset:15360
    s_waitcnt vmcnt(8)
    v_mfma_f32_32x32x16_bf16 v[88:103], a[152:155], a[24:27], v[88:103]
    v_mfma_f32_32x32x16_bf16 v[120:135], a[156:159], a[24:27], v[120:135]
    s_waitcnt vmcnt(6)
    v_cmp_ne_u32 vcc, v43, v42
    s_nop 1
    s_and_b32 s78, vcc_lo, s19
    s_cbranch_scc0 L_fs01_ok
    s_mov_b32 s81, 0
L_fs01_spin:
    buffer_load_dword v43, v44, s[28:31], 0 offen sc1
    s_add_u32 s81, s81, 1
    s_cmp_gt_u32 s81, 50000
    s_cbranch_scc1 L_fs01_ok
    s_waitcnt vmcnt(0)
    v_cmp_ne_u32 vcc, v43, v42
    s_nop 1
    s_and_b32 s78, vcc_lo, s19
    s_cbranch_scc1 L_fs01_spin
L_fs01_ok:
    s_mul_i32 s83, s71, 8
    buffer_load_dwordx4 a[56:59], v24, s[28:31], s83 offen sc1
    v_mfma_f32_32x32x16_bf16 v[104:119], a[152:155], a[28:31], v[104:119]
    v_mfma_f32_32x32x16_bf16 v[136:151], a[156:159], a[28:31], v[136:151]
    buffer_load_dwordx4 a[60:63], v25, s[28:31], s83 offen sc1
    ds_read_b64_tr_b16 a[152:153], v40 offset:0
    ds_read_b64_tr_b16 a[154:155], v40 offset:1024
    ds_read_b64_tr_b16 a[156:157], v41 offset:0
    ds_read_b64_tr_b16 a[158:159], v41 offset:1024
    s_mul_i32 s83, s72, 8
    buffer_load_dwordx4 a[64:67], v24, s[28:31], s83 offen sc1
    s_waitcnt vmcnt(8)
    v_mfma_f32_32x32x16_bf16 v[88:103], a[160:163], a[32:35], v[88:103]
    v_mfma_f32_32x32x16_bf16 v[120:135], a[164:167], a[32:35], v[120:135]
    buffer_load_dwordx4 a[68:71], v25, s[28:31], s83 offen sc1
    s_waitcnt vmcnt(8)
    v_mfma_f32_32x32x16_bf16 v[104:119], a[160:163], a[36:39], v[104:119]
    v_mfma_f32_32x32x16_bf16 v[136:151], a[164:167], a[36:39], v[136:151]
    s_mul_i32 s83, s73, 8
    buffer_load_dwordx4 a[72:75], v24, s[28:31], s83 offen sc1
    ds_read_b64_tr_b16 a[160:161], v40 offset:2048
    ds_read_b64_tr_b16 a[162:163], v40 offset:3072
    ds_read_b64_tr_b16 a[164:165], v41 offset:2048
    ds_read_b64_tr_b16 a[166:167], v41 offset:3072
    s_waitcnt vmcnt(8)
    v_mfma_f32_32x32x16_bf16 v[88:103], a[168:171], a[40:43], v[88:103]
    v_mfma_f32_32x32x16_bf16 v[120:135], a[172:175], a[40:43], v[120:135]
    buffer_load_dwordx4 a[76:79], v25, s[28:31], s83 offen sc1
    s_waitcnt vmcnt(8)
    v_mfma_f32_32x32x16_bf16 v[104:119], a[168:171], a[44:47], v[104:119]
    v_mfma_f32_32x32x16_bf16 v[136:151], a[172:175], a[44:47], v[136:151]
    s_mul_i32 s83, s74, 8
    buffer_load_dwordx4 a[80:83], v24, s[28:31], s83 offen sc1
    ds_read_b64_tr_b16 a[168:169], v40 offset:4096
    ds_read_b64_tr_b16 a[170:171], v40 offset:5120
    ds_read_b64_tr_b16 a[172:173], v41 offset:4096
    ds_read_b64_tr_b16 a[174:175], v41 offset:5120
    s_waitcnt vmcnt(8)
    v_mfma_f32_32x32x16_bf16 v[88:103], a[176:179], a[48:51], v[88:103]
    v_mfma_f32_32x32x16_bf16 v[120:135], a[180:183], a[48:51], v[120:135]
    buffer_load_dwordx4 a[84:87], v25, s[28:31], s83 offen sc1
    s_waitcnt vmcnt(8)
    v_mfma_f32_32x32x16_bf16 v[104:119], a[176:179], a[52:55], v[104:119]
    v_mfma_f32_32x32x16_bf16 v[136:151], a[180:183], a[52:55], v[136:151]
    buffer_load_dword v43, v44, s[28:31], 0 offen offset:128 sc1
    ds_read_b64_tr_b16 a[176:177], v40 offset:6144
    ds_read_b64_tr_b16 a[178:179], v40 offset:7168
    ds_read_b64_tr_b16 a[180:181], v41 offset:6144
    ds_read_b64_tr_b16 a[182:183], v41 offset:7168
    s_waitcnt vmcnt(8)
    v_mfma_f32_32x32x16_bf16 v[88:103], a[184:187], a[56:59], v[88:103]
    v_mfma_f32_32x32x16_bf16 v[120:135], a[188:191], a[56:59], v[120:135]
    s_mul_i32 s83, s75, 8
    buffer_load_dwordx4 a[88:91], v24, s[28:31], s83 offen sc1
    s_waitcnt vmcnt(8)
    v_mfma_f32_32x32x16_bf16 v[104:119], a[184:187], a[60:63], v[104:119]
    v_mfma_f32_32x32x16_bf16 v[136:151], a[188:191], a[60:63], v[136:151]
    buffer_load_dwordx4 a[92:95], v25, s[28:31], s83 offen sc1
    s_waitcnt vmcnt(8)
    v_mfma_f32_32x32x16_bf16 v[88:103], a[192:195], a[64:67], v[88:103]
    v_mfma_f32_32x32x16_bf16 v[120:135], a[196:199], a[64:67], v[120:135]
    s_mul_i32 s83, s76, 8
    buffer_load_dwordx4 a[96:99], v24, s[28:31], s83 offen sc1
    s_waitcnt vmcnt(8)
    v_mfma_f32_32x32x16_bf16 v[104:119], a[192:195], a[68:71], v[104:119]
    v_mfma_f32_32x32x16_bf16 v[136:151], a[196:199], a[68:71], v[136:151]
    buffer_load_dwordx4 a[100:103], v25, s[28:31], s83 offen sc1
    s_waitcnt vmcnt(8)
    v_mfma_f32_32x32x16_bf16 v[88:103], a[200:203], a[72:75], v[88:103]
    v_mfma_f32_32x32x16_bf16 v[120:135], a[204:207], a[72:75], v[120:135]
    s_mul_i32 s83, s77, 8
    buffer_load_dwordx4 a[104:107], v24, s[28:31], s83 offen sc1
    s_waitcnt vmcnt(8)
    v_mfma_f32_32x32x16_bf16 v[104:119], a[200:203], a[76:79], v[104:119]
    v_mfma_f32_32x32x16_bf16 v[136:151], a[204:207], a[76:79], v[136:151]
    buffer_load_dwordx4 a[108:111], v25, s[28:31], s83 offen sc1
    s_waitcnt vmcnt(8)
    v_mfma_f32_32x32x16_bf16 v[88:103], a[208:211], a[80:83], v[88:103]
    v_mfma_f32_32x32x16_bf16 v[120:135], a[212:215], a[80:83], v[120:135]
    s_waitcnt vmcnt(6)
    v_cmp_ne_u32 vcc, v43, v42
    s_nop 1
    s_and_b32 s78, vcc_lo, s18
    s_cbranch_scc0 L_fs10_ok
    s_mov_b32 s81, 0
L_fs10_spin:
    buffer_load_dword v43, v44, s[28:31], 0 offen offset:128 sc1
    s_add_u32 s81, s81, 1
    s_cmp_gt_u32 s81, 50000
    s_cbranch_scc1 L_fs10_ok
    s_waitcnt vmcnt(0)
    v_cmp_ne_u32 vcc, v43, v42
    s_nop 1
    s_and_b32 s78, vcc_lo, s18
    s_cbranch_scc1 L_fs10_spin
L_fs10_ok:
    s_mul_i32 s83, s64, 8
    buffer_load_dwordx4 v[152:155], v26, s[28:31], s83 offen sc1
    v_mfma_f32_32x32x16_bf16 v[104:119], a[208:211], a[84:87], v[104:119]
    v_mfma_f32_32x32x16_bf16 v[136:151], a[212:215], a[84:87], v[136:151]
    buffer_load_dwordx4 v[156:159], v27, s[28:31], s83 offen sc1
    s_mul_i32 s83, s65, 8
    buffer_load_dwordx4 v[160:163], v26, s[28:31], s83 offen sc1
    s_waitcnt vmcnt(8)
    v_mfma_f32_32x32x16_bf16 v[88:103], a[216:219], a[88:91], v[88:103]
    v_mfma_f32_32x32x16_bf16 v[120:135], a[220:223], a[88:91], v[120:135]
    buffer_load_dwordx4 v[164:167], v27, s[28:31], s83 offen sc1
    s_waitcnt vmcnt(8)
    v_mfma_f32_32x32x16_bf16 v[104:119], a[216:219], a[92:95], v[104:119]
    v_mfma_f32_32x32x16_bf16 v[136:151], a[220:223], a[92:95], v[136:151]
    s_mul_i32 s83, s66, 8
    buffer_load_dwordx4 v[168:171], v26, s[28:31], s83 offen sc1
    s_waitcnt vmcnt(8)
    v_mfma_f32_32x32x16_bf16 v[88:103], a[224:227], a[96:99], v[88:103]
    v_mfma_f32_32x32x16_bf16 v[120:135], a[228:231], a[96:99], v[120:135]
    buffer_load_dwordx4 v[172:175], v27, s[28:31], s83 offen sc1
    s_waitcnt vmcnt(8)
    v_mfma_f32_32x32x16_bf16 v[104:119], a[224:227], a[100:103], v[104:119]
    v_mfma_f32_32x32x16_bf16 v[136:151], a[228:231], a[100:103], v[136:151]
    s_mul_i32 s83, s67, 8
    buffer_load_dwordx4 v[176:179], v26, s[28:31], s83 offen sc1
    s_waitcnt vmcnt(8)
    v_mfma_f32_32x32x16_bf16 v[88:103], a[232:235], a[104:107], v[88:103]
    v_mfma_f32_32x32x16_bf16 v[120:135], a[236:239], a[104:107], v[120:135]
    buffer_load_dwordx4 v[180:183], v27, s[28:31], s83 offen sc1
    s_waitcnt vmcnt(8)
    v_mfma_f32_32x32x16_bf16 v[104:119], a[232:235], a[108:111], v[104:119]
    v_mfma_f32_32x32x16_bf16 v[136:151], a[236:239], a[108:111], v[136:151]
    buffer_load_dword v43, v44, s[28:31], 0 offen offset:128 sc1
    s_waitcnt vmcnt(8)
    v_mfma_f32_32x32x16_bf16 v[88:103], a[240:243], v[152:155], v[88:103]
    v_mfma_f32_32x32x16_bf16 v[120:135], a[244:247], v[152:155], v[120:135]
    s_mul_i32 s83, s68, 8
    buffer_load_dwordx4 v[184:187], v26, s[28:31], s83 offen sc1
    s_waitcnt vmcnt(8)
    v_mfma_f32_32x32x16_bf16 v[104:119], a[240:243], v[156:159], v[104:119]
    v_mfma_f32_32x32x16_bf16 v[136:151], a[244:247], v[156:159], v[136:151]
    buffer_load_dwordx4 v[188:191], v27, s[28:31], s83 offen sc1
    s_waitcnt vmcnt(8)
    v_mfma_f32_32x32x16_bf16 v[88:103], a[248:251], v[160:163], v[88:103]
    v_mfma_f32_32x32x16_bf16 v[120:135], a[252:255], v[160:163], v[120:135]
    s_mul_i32 s83, s69, 8
    buffer_load_dwordx4 v[192:195], v26, s[28:31], s83 offen sc1
    s_waitcnt vmcnt(8)
    v_mfma_f32_32x32x16_bf16 v[104:119], a[248:251], v[164:167], v[104:119]
    v_mfma_f32_32x32x16_bf16 v[136:151], a[252:255], v[164:167], v[136:151]
    buffer_load_dwordx4 v[196:199], v27, s[28:31], s83 offen sc1
    s_waitcnt vmcnt(8)
    v_mfma_f32_32x32x16_bf16 v[88:103], v[216:219], v[168:171], v[88:103]
    v_mfma_f32_32x32x16_bf16 v[120:135], v[220:223], v[168:171], v[120:135]
    s_mul_i32 s83, s70, 8
    buffer_load_dwordx4 v[200:203], v26, s[28:31], s83 offen sc1
    s_waitcnt vmcnt(8)
    v_mfma_f32_32x32x16_bf16 v[104:119], v[216:219], v[172:175], v[104:119]
    v_mfma_f32_32x32x16_bf16 v[136:151], v[220:223], v[172:175], v[136:151]
    buffer_load_dwordx4 v[204:207], v27, s[28:31], s83 offen sc1
    s_waitcnt vmcnt(8)
    v_mfma_f32_32x32x16_bf16 v[88:103], v[224:227], v[176:179], v[88:103]
    v_mfma_f32_32x32x16_bf16 v[120:135], v[228:231], v[176:179], v[120:135]
    s_waitcnt vmcnt(6)
    v_cmp_ne_u32 vcc, v43, v42
    s_nop 1
    s_and_b32 s78, vcc_lo, s19
    s_cbranch_scc0 L_fs11_ok
    s_mov_b32 s81, 0
L_fs11_spin:
    buffer_load_dword v43, v44, s[28:31], 0 offen offset:128 sc1
    s_add_u32 s81, s81, 1
    s_cmp_gt_u32 s81, 50000
    s_cbranch_scc1 L_fs11_ok
    s_waitcnt vmcnt(0)
    v_cmp_ne_u32 vcc, v43, v42
    s_nop 1
    s_and_b32 s78, vcc_lo, s19
    s_cbranch_scc1 L_fs11_spin
L_fs11_ok:
    s_mul_i32 s83, s71, 8
    buffer_load_dwordx4 v[208:211], v26, s[28:31], s83 offen sc1
    v_mfma_f32_32x32x16_bf16 v[104:119], v[224:227], v[180:183], v[104:119]
    v_mfma_f32_32x32x16_bf16 v[136:151], v[228:231], v[180:183], v[136:151]
    buffer_load_dwordx4 v[212:215], v27, s[28:31], s83 offen sc1
    s_mul_i32 s83, s72, 8
    buffer_load_dwordx4 v[56:59], v26, s[28:31], s83 offen sc1
    s_waitcnt vmcnt(8)
    v_mfma_f32_32x32x16_bf16 v[88:103], v[232:235], v[184:187], v[88:103]
    v_mfma_f32_32x32x16_bf16 v[120:135], v[236:239], v[184:187], v[120:135]
    buffer_load_dwordx4 v[60:63], v27, s[28:31], s83 offen sc1
    s_waitcnt vmcnt(8)
    v_mfma_f32_32x32x16_bf16 v[104:119], v[232:235], v[188:191], v[104:119]
    v_mfma_f32_32x32x16_bf16 v[136:151], v[236:239], v[188:191], v[136:151]
    s_mul_i32 s83, s73, 8
    buffer_load_dwordx4 v[64:67], v26, s[28:31], s83 offen sc1
    s_waitcnt vmcnt(8)
    v_mfma_f32_32x32x16_bf16 v[88:103], v[240:243], v[192:195], v[88:103]
    v_mfma_f32_32x32x16_bf16 v[120:135], v[244:247], v[192:195], v[120:135]
    buffer_load_dwordx4 v[68:71], v27, s[28:31], s83 offen sc1
    s_waitcnt vmcnt(8)
    v_mfma_f32_32x32x16_bf16 v[104:119], v[240:243], v[196:199], v[104:119]
    v_mfma_f32_32x32x16_bf16 v[136:151], v[244:247], v[196:199], v[136:151]
    s_mul_i32 s83, s74, 8
    buffer_load_dwordx4 v[72:75], v26, s[28:31], s83 offen sc1
    s_waitcnt vmcnt(8)
    s_waitcnt lgkmcnt(15)
    v_mfma_f32_32x32x16_bf16 v[88:103], v[248:251], v[200:203], v[88:103]
    v_mfma_f32_32x32x16_bf16 v[120:135], v[252:255], v[200:203], v[120:135]
    buffer_load_dwordx4 v[76:79], v27, s[28:31], s83 offen sc1
    s_waitcnt vmcnt(8)
    v_mfma_f32_32x32x16_bf16 v[104:119], v[248:251], v[204:207], v[104:119]
    v_mfma_f32_32x32x16_bf16 v[136:151], v[252:255], v[204:207], v[136:151]
    s_mul_i32 s83, s75, 8
    buffer_load_dwordx4 v[80:83], v26, s[28:31], s83 offen sc1
    s_waitcnt vmcnt(8)
    v_mfma_f32_32x32x16_bf16 v[88:103], a[128:131], v[208:211], v[88:103]
    v_mfma_f32_32x32x16_bf16 v[120:135], a[132:135], v[208:211], v[120:135]
    buffer_load_dwordx4 v[84:87], v27, s[28:31], s83 offen sc1
    s_waitcnt vmcnt(8)
    v_mfma_f32_32x32x16_bf16 v[104:119], a[128:131], v[212:215], v[104:119]
    v_mfma_f32_32x32x16_bf16 v[136:151], a[132:135], v[212:215], v[136:151]
    s_mul_i32 s83, s76, 8
    buffer_load_dwordx4 a[112:115], v26, s[28:31], s83 offen sc1
    s_waitcnt vmcnt(8)
    v_mfma_f32_32x32x16_bf16 v[88:103], a[136:139], v[56:59], v[88:103]
    v_mfma_f32_32x32x16_bf16 v[120:135], a[140:143], v[56:59], v[120:135]
    buffer_load_dwordx4 a[116:119], v27, s[28:31], s83 offen sc1
    s_waitcnt vmcnt(8)
    v_mfma_f32_32x32x16_bf16 v[104:119], a[136:139], v[60:63], v[104:119]
    v_mfma_f32_32x32x16_bf16 v[136:151], a[140:143], v[60:63], v[136:151]
    s_mul_i32 s83, s77, 8
    buffer_load_dwordx4 a[120:123], v26, s[28:31], s83 offen sc1
    s_waitcnt vmcnt(8)
    v_mfma_f32_32x32x16_bf16 v[88:103], a[144:147], v[64:67], v[88:103]
    v_mfma_f32_32x32x16_bf16 v[120:135], a[148:151], v[64:67], v[120:135]
    buffer_load_dwordx4 a[124:127], v27, s[28:31], s83 offen sc1
    s_waitcnt vmcnt(8)
    v_mfma_f32_32x32x16_bf16 v[104:119], a[144:147], v[68:71], v[104:119]
    v_mfma_f32_32x32x16_bf16 v[136:151], a[148:151], v[68:71], v[136:151]
    s_waitcnt vmcnt(7)
    s_waitcnt lgkmcnt(12)
    v_mfma_f32_32x32x16_bf16 v[88:103], a[152:155], v[72:75], v[88:103]
    v_mfma_f32_32x32x16_bf16 v[120:135], a[156:159], v[72:75], v[120:135]
    s_waitcnt vmcnt(6)
    v_mfma_f32_32x32x16_bf16 v[104:119], a[152:155], v[76:79], v[104:119]
    v_mfma_f32_32x32x16_bf16 v[136:151], a[156:159], v[76:79], v[136:151]
    s_waitcnt vmcnt(5)
    s_waitcnt lgkmcnt(8)
    v_mfma_f32_32x32x16_bf16 v[88:103], a[160:163], v[80:83], v[88:103]
    v_mfma_f32_32x32x16_bf16 v[120:135], a[164:167], v[80:83], v[120:135]
    s_waitcnt vmcnt(4)
    v_mfma_f32_32x32x16_bf16 v[104:119], a[160:163], v[84:87], v[104:119]
    v_mfma_f32_32x32x16_bf16 v[136:151], a[164:167], v[84:87], v[136:151]
    s_waitcnt vmcnt(3)
    s_waitcnt lgkmcnt(4)
    v_mfma_f32_32x32x16_bf16 v[88:103], a[168:171], a[112:115], v[88:103]
    v_mfma_f32_32x32x16_bf16 v[120:135], a[172:175], a[112:115], v[120:135]
    s_waitcnt vmcnt(2)
    v_mfma_f32_32x32x16_bf16 v[104:119], a[168:171], a[116:119], v[104:119]
    v_mfma_f32_32x32x16_bf16 v[136:151], a[172:175], a[116:119], v[136:151]
    s_waitcnt vmcnt(1)
    s_waitcnt lgkmcnt(0)
    v_mfma_f32_32x32x16_bf16 v[88:103], a[176:179], a[120:123], v[88:103]
    v_mfma_f32_32x32x16_bf16 v[120:135], a[180:183], a[120:123], v[120:135]
    s_waitcnt vmcnt(0)
    v_mfma_f32_32x32x16_bf16 v[104:119], a[176:179], a[124:127], v[104:119]
    v_mfma_f32_32x32x16_bf16 v[136:151], a[180:183], a[124:127], v[136:151]
L_red:
    v_and_b32 v5, 31, v2
    v_mul_u32_u24 v5, 272, v5
    v_lshrrev_b32 v6, 5, v2
    v_lshlrev_b32 v6, 4, v6
    s_mul_i32 s78, s3, 17408
    v_add3_u32 v12, v5, v6, s78
    v_lshrrev_b32 v5, 3, v0
    v_mul_u32_u24 v6, 272, v5
    v_and_b32 v7, 7, v0
    v_lshlrev_b32 v13, 5, v7
    v_add_u32 v13, v13, v6
    v_lshlrev_b32 v5, 10, v5
    v_lshlrev_b32 v7, 4, v7
    v_add3_u32 v14, v5, v7, s14
    v_add_u32 v15, 34816, v13
    ds_write_b128 v12, v[88:91] offset:0
    ds_write_b128 v12, v[92:95] offset:32
    ds_write_b128 v12, v[96:99] offset:64
    ds_write_b128 v12, v[100:103] offset:96
    ds_write_b128 v12, v[120:123] offset:128
    ds_write_b128 v12, v[124:127] offset:160
    ds_write_b128 v12, v[128:131] offset:192
    ds_write_b128 v12, v[132:135] offset:224
    ds_write_b128 v12, v[104:107] offset:8704
    ds_write_b128 v12, v[108:111] offset:8736
    ds_write_b128 v12, v[112:115] offset:8768
    ds_write_b128 v12, v[116:119] offset:8800
    ds_write_b128 v12, v[136:139] offset:8832
    ds_write_b128 v12, v[140:143] offset:8864
    ds_write_b128 v12, v[144:147] offset:8896
    ds_write_b128 v12, v[148:151] offset:8928
    s_waitcnt lgkmcnt(0)
    s_barrier
    ds_read_b128 v[152:155], v13 offset:0
    ds_read_b128 v[156:159], v13 offset:16
    ds_read_b128 v[160:163], v13 offset:17408
    ds_read_b128 v[164:167], v13 offset:17424
    ds_read_b128 v[168:171], v15 offset:0
    ds_read_b128 v[172:175], v15 offset:16
    ds_read_b128 v[176:179], v15 offset:17408
    ds_read_b128 v[180:183], v15 offset:17424
    ds_read_b128 v[184:187], v13 offset:8704
    ds_read_b128 v[188:191], v13 offset:8720
    ds_read_b128 v[192:195], v13 offset:26112
    ds_read_b128 v[196:199], v13 offset:26128
    ds_read_b128 v[200:203], v15 offset:8704
    ds_read_b128 v[204:207], v15 offset:8720
    ds_read_b128 v[208:211], v15 offset:26112
    ds_read_b128 v[212:215], v15 offset:26128
    s_or_b32 s78, s41, s3
    s_or_b32 s78, s78, s43
    s_cmp_lg_u32 s78, 0
    s_cbranch_scc1 L_nobump
    s_mov_b64 exec, 1
    buffer_store_dword v42, v45, s[28:31], s15 offen sc1
    s_mov_b64 exec, -1
L_nobump:
    s_waitcnt lgkmcnt(8)
    v_add_f32 v152, v152, v160
    v_add_f32 v168, v168, v176
    v_add_f32 v153, v153, v161
    v_add_f32 v169, v169, v177
    v_add_f32 v154, v154, v162
    v_add_f32 v170, v170, v178
    v_add_f32 v155, v155, v163
    v_add_f32 v171, v171, v179
    v_add_f32 v156, v156, v164
    v_add_f32 v172, v172, v180
    v_add_f32 v157, v157, v165
    v_add_f32 v173, v173, v181
    v_add_f32 v158, v158, v166
    v_add_f32 v174, v174, v182
    v_add_f32 v159, v159, v167
    v_add_f32 v175, v175, v183
    v_add_f32 v152, v152, v168
    v_add_f32 v153, v153, v169
    v_add_f32 v154, v154, v170
    v_add_f32 v155, v155, v171
    v_add_f32 v156, v156, v172
    v_add_f32 v157, v157, v173
    v_add_f32 v158, v158, v174
    v_add_f32 v159, v159, v175
    v_cvt_pk_bf16_f32 v48, v152, v153
    v_cvt_pk_bf16_f32 v49, v154, v155
    v_cvt_pk_bf16_f32 v50, v156, v157
    v_cvt_pk_bf16_f32 v51, v158, v159
    s_mov_b32 s79, 0
    buffer_store_dwordx4 v[48:51], v14, s[36:39], s79 offen
    s_waitcnt lgkmcnt(0)
    v_add_f32 v184, v184, v192
    v_add_f32 v200, v200, v208
    v_add_f32 v185, v185, v193
    v_add_f32 v201, v201, v209
    v_add_f32 v186, v186, v194
    v_add_f32 v202, v202, v210
    v_add_f32 v187, v187, v195
    v_add_f32 v203, v203, v211
    v_add_f32 v188, v188, v196
    v_add_f32 v204, v204, v212
    v_add_f32 v189, v189, v197
    v_add_f32 v205, v205, v213
    v_add_f32 v190, v190, v198
    v_add_f32 v206, v206, v214
    v_add_f32 v191, v191, v199
    v_add_f32 v207, v207, v215
    v_add_f32 v184, v184, v200
    v_add_f32 v185, v185, v201
    v_add_f32 v186, v186, v202
    v_add_f32 v187, v187, v203
    v_add_f32 v188, v188, v204
    v_add_f32 v189, v189, v205
    v_add_f32 v190, v190, v206
    v_add_f32 v191, v191, v207
    v_cvt_pk_bf16_f32 v52, v184, v185
    v_cvt_pk_bf16_f32 v53, v186, v187
    v_cvt_pk_bf16_f32 v54, v188, v189
    v_cvt_pk_bf16_f32 v55, v190, v191
    s_mov_b32 s79, 32768
    buffer_store_dwordx4 v[52:55], v14, s[36:39], s79 offen
L_end:
    s_endpgm

.section .rodata,"a"
.p2align 6
.amdhsa_kernel standalone__glu_gated_reglu__prompt_kernel
  .amdhsa_next_free_vgpr 512
  .amdhsa_next_free_sgpr 102
  .amdhsa_accum_offset 256
  .amdhsa_group_segment_fixed_size 0
  .amdhsa_kernarg_size 56
  .amdhsa_user_sgpr_count 2
  .amdhsa_user_sgpr_kernarg_segment_ptr 1
  .amdhsa_system_sgpr_workgroup_id_x 1
.end_amdhsa_kernel
```
